```python
import torch

def _softmax(x, axis=-1):
    return torch.softmax(x, dim=axis)
def _gelu(x):
    return torch.nn.functional.gelu(x, approximate="tanh")
def _silu(x):
    return torch.nn.functional.silu(x)
def _sigmoid(x):
    return torch.sigmoid(x)
def _layernorm(x, axis=-1, eps=1e-5):
    m = x.mean(dim=axis, keepdim=True)
    v = x.var(dim=axis, keepdim=True, unbiased=False)
    return (x - m) / torch.sqrt(v + eps)
def _scatter_add(tgt, idx, src, axis=0):
    return tgt.clone().index_add_(axis, idx, src)
def _segment_sum(src, seg, n):
    out = torch.zeros((n,) + src.shape[1:], dtype=src.dtype)
    return out.index_add_(0, seg, src)
def _pad(x, pw):
    flat = tuple(v for pair in reversed(pw) for v in pair)
    return torch.nn.functional.pad(x, flat)

kernel_name = 'interleave_layers__compressed_kv_cla__glu_gated_geglu__decode'

def setup_inputs():

    _w = (lambda a: (lambda t: t.to(torch.bfloat16) if t.is_floating_point() else t)(torch.as_tensor(a)))
    def _A_setup():
        B, H, Sq, Sk, D, M = 1, 32, 1, 8192, 128, 640
        Dc = 4 * D
        return {
            "x": _w((lambda *s: torch.randn(*s, dtype=torch.bfloat16) * 0.05)(B, Sq, M)),
            "c_kv": _w((lambda *s: torch.randn(*s, dtype=torch.bfloat16) * 0.8)(B, Sk, Dc)),
            "w_q": _w((lambda *s: torch.randn(*s, dtype=torch.bfloat16) * 1.6)(M, H, D) * (M ** -0.5)),
            "w_uk": _w((lambda *s: torch.randn(*s, dtype=torch.bfloat16) * 1.6)(Dc, H, D) * (Dc ** -0.5)),
            "w_uv": _w((lambda *s: torch.randn(*s, dtype=torch.bfloat16) * 0.8)(Dc, H, D) * (Dc ** -0.5)),
            "w_o": _w((lambda *s: torch.randn(*s, dtype=torch.bfloat16) * 0.8)(H, D, M) * ((H * D) ** -0.5)),
        }
    _A_in = _A_setup()

    def _B_setup():
        B, S, Dm, Df = 1, 1, 640, 1728
        return {
            "x": _w((lambda *s: torch.randn(*s, dtype=torch.bfloat16) * 0.05)(B, S, Dm)),
            "w_gate": _w((lambda *s: torch.randn(*s, dtype=torch.bfloat16) * 0.4)(Dm, Df) * (Dm ** -0.5)),
            "w_up": _w((lambda *s: torch.randn(*s, dtype=torch.bfloat16) * 0.4)(Dm, Df) * (Dm ** -0.5)),
            "w_down": _w((lambda *s: torch.randn(*s, dtype=torch.bfloat16) * 0.4)(Df, Dm) * (Df ** -0.5)),
        }
    _B_in = _B_setup()

    return {
        "A_x": _A_in["x"],
        "A_c_kv": _A_in["c_kv"],
        "A_w_q": _A_in["w_q"],
        "A_w_uk": _A_in["w_uk"],
        "A_w_uv": _A_in["w_uv"],
        "A_w_o": _A_in["w_o"],
        "B_x": _B_in["x"],
        "B_w_gate": _B_in["w_gate"],
        "B_w_up": _B_in["w_up"],
        "B_w_down": _B_in["w_down"],
    }

def reference(A_x, A_c_kv, A_w_q, A_w_uk, A_w_uv, A_w_o, B_x, B_w_gate, B_w_up, B_w_down):
    def _A_ref(x, c_kv, w_q, w_uk, w_uv, w_o):
        B, Sq, M = x.shape[0], x.shape[1], x.shape[2]
        Sk = c_kv.shape[1]
        H, D = w_q.shape[1], w_q.shape[2]
        q = torch.einsum("bqm,mhd->bhqd", x, w_q)
        k = torch.einsum("bkc,chd->bhkd", c_kv, w_uk)
        v = torch.einsum("bkc,chd->bhkd", c_kv, w_uv)
        scores = torch.einsum("bhqd,bhkd->bhqk", q, k) * (D ** -0.5)
        off = Sk - Sq
        qi = torch.arange(Sq)[:, None]
        kj = torch.arange(Sk)[None, :]
        cmask = kj <= (qi + off)
        scores = torch.where(cmask[None, None], scores, -1e9)
        p = _softmax(scores, axis=-1)
        ctx = torch.einsum("bhqk,bhkd->bhqd", p, v)
        return torch.einsum("bhqd,hdm->bqm", ctx, w_o)

    def _B_ref(x, w_gate, w_up, w_down):
        g = torch.einsum("bsd,df->bsf", x, w_gate)
        u = torch.einsum("bsd,df->bsf", x, w_up)
        h = _gelu(g) * u
        return torch.einsum("bsf,fd->bsd", h, w_down)

    x = A_x
    x = x + _A_ref(_layernorm(x, axis=-1), A_c_kv, A_w_q, A_w_uk, A_w_uv, A_w_o)
    x = x + _B_ref(_layernorm(x, axis=-1), B_w_gate, B_w_up, B_w_down)
    x = x + _A_ref(_layernorm(x, axis=-1), A_c_kv, A_w_q, A_w_uk, A_w_uv, A_w_o)
    x = x + _B_ref(_layernorm(x, axis=-1), B_w_gate, B_w_up, B_w_down)
    return x
```

```asm
; @launch grid=(256,1,1) block=(1024,1,1) lds=163840
.amdgcn_target "amdgcn-amd-amdhsa--gfx950"
.text
.globl interleave_layers__compressed_kv_cla__glu_gated_geglu__decode_kernel
.p2align 8
.type interleave_layers__compressed_kv_cla__glu_gated_geglu__decode_kernel,@function
interleave_layers__compressed_kv_cla__glu_gated_geglu__decode_kernel:
  s_cmp_ge_u32 s2, 256
  s_cbranch_scc1 END
  s_load_dwordx16 s[32:47], s[0:1], 0
  s_load_dwordx8 s[48:55], s[0:1], 64
  s_load_dwordx2 s[56:57], s[0:1], 96
  v_and_b32 v1, 63, v0
  v_lshrrev_b32 v4, 6, v0
  v_lshrrev_b32 v2, 4, v1
  v_readfirstlane_b32 s4, v4
  v_and_b32 v3, 15, v0
  s_and_b32 s5, s2, 7
  s_lshr_b32 s6, s2, 3
  s_mov_b32 s12, 0x20000
  s_mov_b32 s11, 1048576
  s_mov_b32 s13, 4194304
  s_mov_b32 s31, 0
  s_mov_b32 s58, 0
  v_lshlrev_b32 v4, 2, v0
  v_mov_b32 v5, 0x3f803f80
  v_cmp_gt_u32 vcc, 80, v0
  s_nop 0
  s_and_saveexec_b64 s[26:27], vcc
  ds_write_b32 v4, v5 offset:1280
  s_mov_b64 exec, -1
  s_mov_b32 s76, 0x00030003
  s_mov_b32 s77, 0x00030003
  s_mov_b32 s78, 0x00010001
  s_mov_b32 s79, 0x00010001
  s_waitcnt lgkmcnt(0)
  s_load_dword s7, s[56:57], 0
  s_mov_b32 s3, 5242880
  v_mov_b32 v8, -1
  v_mov_b32 v9, -1
  v_mov_b32 v10, -1
  v_mov_b32 v11, -1
  s_mov_b32 s60, s56
  s_mov_b32 s61, s57
  s_mov_b32 s62, 33554432
  s_mov_b32 s63, 0x00020000
  s_cmp_ge_u32 s6, 16
  s_cbranch_scc1 PROLE
  s_lshr_b32 s14, s6, 1
  s_lshl_b32 s8, s5, 3
  s_add_u32 s8, s8, s14
  s_and_b32 s9, s6, 1
  s_lshl_b32 s10, s14, 3
  s_add_u32 s10, s10, s5
  s_lshl_b32 s10, s10, 1
  s_add_u32 s10, s10, s9
  v_lshlrev_b32 v4, 4, v1
  s_mov_b32 s64, s34
  s_mov_b32 s65, s35
  s_mov_b32 s66, 8388608
  s_mov_b32 s67, 0x00020000
  s_lshl_b32 s14, s9, 4
  s_add_u32 s14, s14, s4
  s_lshl_b32 s14, s14, 16
  s_lshl_b32 s15, s8, 8
  s_add_u32 s14, s14, s15
  s_add_u32 s14, s14, 1048576
  v_lshlrev_b32 v6, 14, v2
  v_lshl_add_u32 v6, v3, 4, v6
  v_add_u32 v6, s14, v6
  buffer_store_dwordx4 v[8:11], v6, s[60:63], s11 offen sc1
  s_lshl_b32 s14, s8, 17
  s_lshl_b32 s15, s4, 13
  s_add_u32 s14, s14, s15
  s_mul_i32 s15, s4, 8448
  s_add_u32 s15, s15, 28672
  s_lshl_b32 s16, s9, 12
  s_mul_i32 s17, s9, 4224
  s_add_u32 s18, s14, s16
  s_add_u32 s19, s15, s17
  s_sub_u32 s14, s14, s16
  s_sub_u32 s15, s15, s17
  s_add_u32 s14, s14, 4096
  s_add_u32 s15, s15, 4224
  s_mov_b32 m0, s19
  s_nop 0
  buffer_load_dwordx4 v4, s[64:67], s18 offen nt lds
  s_add_u32 s18, s18, 1024
  s_add_u32 s19, s19, 1056
  s_mov_b32 m0, s19
  s_nop 0
  buffer_load_dwordx4 v4, s[64:67], s18 offen nt lds
  s_add_u32 s18, s18, 1024
  s_add_u32 s19, s19, 1056
  s_cmp_lt_u32 s10, 54
  s_cbranch_scc1 A_TH2
  s_waitcnt vmcnt(1)
A_TH2:
  s_mov_b32 m0, s19
  s_nop 0
  buffer_load_dwordx4 v4, s[64:67], s18 offen nt lds
  s_add_u32 s18, s18, 1024
  s_add_u32 s19, s19, 1056
  s_cmp_lt_u32 s10, 54
  s_cbranch_scc1 A_TH3
  s_waitcnt vmcnt(1)
A_TH3:
  s_mov_b32 m0, s19
  s_nop 0
  buffer_load_dwordx4 v4, s[64:67], s18 offen nt lds
  s_cmp_lt_u32 s10, 54
  s_cbranch_scc1 A_TH4
  s_waitcnt vmcnt(1)
A_TH4:
  s_mov_b32 m0, s15
  s_nop 0
  buffer_load_dwordx4 v4, s[64:67], s14 offen nt lds
  s_add_u32 s14, s14, 1024
  s_add_u32 s15, s15, 1056
  s_cmp_lt_u32 s10, 54
  s_cbranch_scc1 A_TH5
  s_waitcnt vmcnt(1)
A_TH5:
  s_mov_b32 m0, s15
  s_nop 0
  buffer_load_dwordx4 v4, s[64:67], s14 offen nt lds
  s_add_u32 s14, s14, 1024
  s_add_u32 s15, s15, 1056
  s_cmp_lt_u32 s10, 54
  s_cbranch_scc1 A_TH6
  s_waitcnt vmcnt(1)
A_TH6:
  s_mov_b32 m0, s15
  s_nop 0
  buffer_load_dwordx4 v4, s[64:67], s14 offen nt lds
  s_add_u32 s14, s14, 1024
  s_add_u32 s15, s15, 1056
  s_cmp_lt_u32 s10, 54
  s_cbranch_scc1 A_TH7
  s_waitcnt vmcnt(1)
A_TH7:
  s_mov_b32 m0, s15
  s_nop 0
  buffer_load_dwordx4 v4, s[64:67], s14 offen nt lds
  s_cmp_ge_u32 s10, 54
  s_cbranch_scc1 A_NC
  s_cmp_ge_u32 s4, 4
  s_cbranch_scc1 A_NC
  s_lshr_b32 s14, s4, 1
  s_mul_i32 s14, s14, 54
  s_cmp_eq_u32 s10, 0
  s_cselect_b32 s14, s14, s10
  s_mul_i32 s14, s14, 1280
  s_add_u32 s14, s14, 393216
  v_and_b32 v5, 127, v0
  v_lshl_add_u32 v6, v5, 4, s14
  v_cmp_gt_u32 vcc, 80, v5
  v_mov_b32 v7, 0x7ff00000
  s_nop 0
  v_cndmask_b32 v6, v7, v6, vcc
  buffer_store_dwordx4 v[8:11], v6, s[60:63], s11 offen sc1
  buffer_store_dwordx4 v[8:11], v6, s[60:63], s3 offen sc1
  s_waitcnt vmcnt(2)
  s_nop 0
  s_branch A_NC2
A_NC:
  s_waitcnt vmcnt(0)
A_NC2:
  s_waitcnt lgkmcnt(0)
  s_mul_i32 s7, s7, 1664525
  s_add_u32 s7, s7, 1013904223
  s_barrier
  s_cmp_ge_u32 s4, 8
  s_cbranch_scc1 A_VFR
  s_lshl_b32 s14, s4, 4
  v_add_u32 v4, s14, v3
  v_mul_u32_u24 v4, 1056, v4
  v_lshl_add_u32 v4, v2, 4, v4
  ds_read_b128 v[64:67], v4 offset:28672
  ds_read_b128 v[68:71], v4 offset:28736
  ds_read_b128 v[72:75], v4 offset:28800
  ds_read_b128 v[76:79], v4 offset:28864
  ds_read_b128 v[80:83], v4 offset:28928
  ds_read_b128 v[84:87], v4 offset:28992
  ds_read_b128 v[88:91], v4 offset:29056
  ds_read_b128 v[92:95], v4 offset:29120
  ds_read_b128 v[96:99], v4 offset:29184
  ds_read_b128 v[100:103], v4 offset:29248
  ds_read_b128 v[104:107], v4 offset:29312
  ds_read_b128 v[108:111], v4 offset:29376
  ds_read_b128 v[112:115], v4 offset:29440
  ds_read_b128 v[116:119], v4 offset:29504
  ds_read_b128 v[120:123], v4 offset:29568
  ds_read_b128 v[124:127], v4 offset:29632
  s_waitcnt lgkmcnt(0)
  s_barrier
  s_branch A_LOOP
A_VFR:
  v_lshrrev_b32 v4, 2, v1
  v_mul_u32_u24 v4, 1056, v4
  v_and_b32 v5, 3, v1
  v_lshl_add_u32 v4, v5, 3, v4
  s_sub_u32 s14, s4, 8
  s_lshl_b32 s14, s14, 7
  s_add_u32 s14, s14, 28672
  v_add_u32 v4, s14, v4
  v_add_u32 v5, 67584, v4
  ds_read_b64_tr_b16 v[64:65], v4 offset:0
  ds_read_b64_tr_b16 v[66:67], v4 offset:16896
  ds_read_b64_tr_b16 v[80:81], v4 offset:32
  ds_read_b64_tr_b16 v[82:83], v4 offset:16928
  ds_read_b64_tr_b16 v[96:97], v4 offset:64
  ds_read_b64_tr_b16 v[98:99], v4 offset:16960
  ds_read_b64_tr_b16 v[112:113], v4 offset:96
  ds_read_b64_tr_b16 v[114:115], v4 offset:16992
  ds_read_b64_tr_b16 v[68:69], v4 offset:33792
  ds_read_b64_tr_b16 v[70:71], v4 offset:50688
  ds_read_b64_tr_b16 v[84:85], v4 offset:33824
  ds_read_b64_tr_b16 v[86:87], v4 offset:50720
  ds_read_b64_tr_b16 v[100:101], v4 offset:33856
  ds_read_b64_tr_b16 v[102:103], v4 offset:50752
  ds_read_b64_tr_b16 v[116:117], v4 offset:33888
  ds_read_b64_tr_b16 v[118:119], v4 offset:50784
  ds_read_b64_tr_b16 v[72:73], v5 offset:0
  ds_read_b64_tr_b16 v[74:75], v5 offset:16896
  ds_read_b64_tr_b16 v[88:89], v5 offset:32
  ds_read_b64_tr_b16 v[90:91], v5 offset:16928
  ds_read_b64_tr_b16 v[104:105], v5 offset:64
  ds_read_b64_tr_b16 v[106:107], v5 offset:16960
  ds_read_b64_tr_b16 v[120:121], v5 offset:96
  ds_read_b64_tr_b16 v[122:123], v5 offset:16992
  ds_read_b64_tr_b16 v[76:77], v5 offset:33792
  ds_read_b64_tr_b16 v[78:79], v5 offset:50688
  ds_read_b64_tr_b16 v[92:93], v5 offset:33824
  ds_read_b64_tr_b16 v[94:95], v5 offset:50720
  ds_read_b64_tr_b16 v[108:109], v5 offset:33856
  ds_read_b64_tr_b16 v[110:111], v5 offset:50752
  ds_read_b64_tr_b16 v[124:125], v5 offset:33888
  ds_read_b64_tr_b16 v[126:127], v5 offset:50784
  s_waitcnt lgkmcnt(0)
  s_barrier
  s_cmp_ge_u32 s10, 54
  s_cbranch_scc1 A_LOOP
  s_mov_b32 s64, s46
  s_mov_b32 s65, s47
  s_mov_b32 s66, 2211840
  s_mov_b32 s67, 0x00020000
  s_mov_b32 s68, s48
  s_mov_b32 s69, s49
  s_mov_b32 s70, 2211840
  s_mov_b32 s71, 0x00020000
  s_mov_b32 s72, s50
  s_mov_b32 s73, s51
  s_mov_b32 s74, 2211840
  s_mov_b32 s75, 0x00020000
  v_lshrrev_b32 v4, 2, v1
  v_mul_u32_u24 v4, 3456, v4
  v_lshrrev_b32 v5, 5, v1
  v_lshlrev_b32 v5, 1, v5
  v_and_b32 v6, 3, v1
  v_xor_b32 v5, v5, v6
  v_lshl_add_u32 v4, v5, 4, v4
  v_mul_u32_u24 v5, 1280, v2
  s_bfe_u32 s14, s4, 0x10001
  s_lshl_b32 s14, s14, 3
  v_lshl_or_b32 v6, v2, 1, s14
  v_xor_b32 v6, v6, v3
  v_lshl_add_u32 v5, v6, 4, v5
  s_and_b32 s18, s4, 7
  s_mul_i32 s14, s18, 55296
  s_lshl_b32 s15, s10, 6
  s_add_u32 s14, s14, s15
  s_lshl_b32 s15, s18, 10
  s_mul_i32 s16, s10, 40960
  s_mul_i32 s17, s18, 5120
  s_add_u32 s16, s16, s17
  s_add_u32 s18, s14, 0
  s_add_u32 s17, s15, 40960
  s_mov_b32 m0, s17
  s_nop 0
  buffer_load_dwordx4 v4, s[64:67], s18 offen nt lds
  s_add_u32 s17, s15, 81920
  s_mov_b32 m0, s17
  s_nop 0
  buffer_load_dwordx4 v4, s[68:71], s18 offen nt lds
  s_add_u32 s18, s14, 442368
  s_add_u32 s17, s15, 49152
  s_mov_b32 m0, s17
  s_nop 0
  buffer_load_dwordx4 v4, s[64:67], s18 offen nt lds
  s_add_u32 s17, s15, 90112
  s_mov_b32 m0, s17
  s_nop 0
  buffer_load_dwordx4 v4, s[68:71], s18 offen nt lds
A_LOOP:
  s_lshl_b32 s14, s9, 4
  s_add_u32 s14, s14, s4
  s_lshl_b32 s14, s14, 10
  s_add_u32 s14, s14, 131072
  v_lshl_add_u32 v4, v1, 4, s14
  s_mul_i32 s15, s4, 1056
  v_lshl_add_u32 v6, v1, 4, s15
  v_mul_u32_u24 v12, 1056, v3
  v_lshl_add_u32 v12, v2, 4, v12
  s_cmp_lg_u32 s4, 0
  s_nop 0
  s_cbranch_scc1 A_SC
  s_lshl_b32 s14, s9, 13
  v_lshl_add_u32 v16, v1, 7, s14
  s_nop 1
POLL_1:
  buffer_load_dwordx4 v[8:11], v16, s[60:63], s11 offen offset:0 sc1
  s_waitcnt vmcnt(0)
  v_xor_b32 v14, s7, v9
  v_xor_b32 v13, s7, v11
  v_or_b32 v14, v14, v13
  v_cmp_ne_u32 vcc, 0, v14
  s_nop 4
  s_cbranch_vccz PDONE_2
  s_sub_u32 s12, s12, 1
  s_cbranch_scc0 POLL_1
  s_mov_b32 s12, 0
PDONE_2:
A_SC:
  s_add_u32 s16, s11, 8192
  s_barrier
  s_cmp_ge_u32 s4, 8
  s_cbranch_scc1 A_H1
POLL_3:
  buffer_load_dwordx4 v[8:11], v4, s[60:63], s11 offen offset:0 sc1
  buffer_load_dwordx4 v[16:19], v4, s[60:63], s16 offen offset:0 sc1
  s_waitcnt vmcnt(1)
  v_max3_u32 v15, v8, v9, v10
  v_max_u32 v15, v15, v11
  s_waitcnt vmcnt(0)
  v_max3_u32 v15, v15, v16, v17
  v_max3_u32 v15, v15, v18, v19
  v_cmp_eq_u32 vcc, -1, v15
  s_nop 4
  s_cbranch_vccz PDONE_4
  s_sub_u32 s12, s12, 1
  s_cbranch_scc0 POLL_3
  s_mov_b32 s12, 0
PDONE_4:
  ds_write_b128 v6, v[8:11] offset:1600
  ds_write_b128 v6, v[16:19] offset:10048
A_H1:
  s_waitcnt lgkmcnt(0)
  s_barrier
  s_cmp_lt_u32 s4, 8
  s_cbranch_scc1 A_QK
  s_cmp_lg_u32 s58, 0
  s_cbranch_scc1 A_NMID
  s_cmp_ge_u32 s10, 54
  s_cbranch_scc1 A_NMID
  s_mov_b32 s64, s46
  s_mov_b32 s65, s47
  s_mov_b32 s66, 2211840
  s_mov_b32 s67, 0x00020000
  s_mov_b32 s68, s48
  s_mov_b32 s69, s49
  s_mov_b32 s70, 2211840
  s_mov_b32 s71, 0x00020000
  s_mov_b32 s72, s50
  s_mov_b32 s73, s51
  s_mov_b32 s74, 2211840
  s_mov_b32 s75, 0x00020000
  v_lshrrev_b32 v4, 2, v1
  v_mul_u32_u24 v4, 3456, v4
  v_lshrrev_b32 v5, 5, v1
  v_lshlrev_b32 v5, 1, v5
  v_and_b32 v6, 3, v1
  v_xor_b32 v5, v5, v6
  v_lshl_add_u32 v4, v5, 4, v4
  v_mul_u32_u24 v5, 1280, v2
  s_bfe_u32 s14, s4, 0x10001
  s_lshl_b32 s14, s14, 3
  v_lshl_or_b32 v6, v2, 1, s14
  v_xor_b32 v6, v6, v3
  v_lshl_add_u32 v5, v6, 4, v5
  s_and_b32 s18, s4, 7
  s_mul_i32 s14, s18, 55296
  s_lshl_b32 s15, s10, 6
  s_add_u32 s14, s14, s15
  s_lshl_b32 s15, s18, 10
  s_mul_i32 s16, s10, 40960
  s_mul_i32 s17, s18, 5120
  s_add_u32 s16, s16, s17
  s_add_u32 s17, s15, 122880
  s_add_u32 s18, s16, 0
  s_mov_b32 m0, s17
  s_nop 0
  buffer_load_dwordx4 v5, s[72:75], s18 offen nt lds
  s_add_u32 s17, s15, 131072
  s_add_u32 s18, s16, 256
  s_mov_b32 m0, s17
  s_nop 0
  buffer_load_dwordx4 v5, s[72:75], s18 offen nt lds
  s_add_u32 s17, s15, 139264
  s_add_u32 s18, s16, 512
  s_mov_b32 m0, s17
  s_nop 0
  buffer_load_dwordx4 v5, s[72:75], s18 offen nt lds
  s_add_u32 s17, s15, 147456
  s_add_u32 s18, s16, 768
  s_mov_b32 m0, s17
  s_nop 0
  buffer_load_dwordx4 v5, s[72:75], s18 offen nt lds
  s_add_u32 s17, s15, 155648
  s_add_u32 s18, s16, 1024
  s_mov_b32 m0, s17
  s_nop 0
  buffer_load_dwordx4 v5, s[72:75], s18 offen nt lds
A_NMID:
  v_mul_u32_u24 v15, 288, v3
  v_lshl_add_u32 v15, v2, 4, v15
  s_sub_u32 s14, s4, 8
  s_lshr_b32 s15, s14, 1
  s_lshl_b32 s15, s15, 14
  s_and_b32 s14, s14, 1
  s_lshl_b32 s14, s14, 7
  s_add_u32 s14, s14, s15
  s_lshl_b32 s15, s8, 8
  s_add_u32 s14, s14, s15
  s_lshl_b32 s15, s9, 20
  s_add_u32 s14, s14, s15
  s_add_u32 s14, s14, 1048576
  v_and_b32 v4, 7, v3
  v_lshlrev_b32 v4, 16, v4
  v_lshl_add_u32 v4, v2, 4, v4
  v_lshrrev_b32 v5, 3, v3
  v_lshl_add_u32 v4, v5, 6, v4
  v_add_u32 v4, s14, v4
  v_add_u32 v5, 0x80000, v4
  s_nop 1
  s_branch A_B2
A_QK:
  ds_read_b128 v[16:19], v12 offset:1600
  ds_read_b128 v[20:23], v12 offset:1664
  ds_read_b128 v[24:27], v12 offset:1728
  ds_read_b128 v[28:31], v12 offset:1792
  ds_read_b128 v[32:35], v12 offset:1856
  ds_read_b128 v[36:39], v12 offset:1920
  ds_read_b128 v[40:43], v12 offset:1984
  ds_read_b128 v[44:47], v12 offset:2048
  ds_read_b128 v[48:51], v12 offset:2112
  ds_read_b128 v[52:55], v12 offset:2176
  ds_read_b128 v[56:59], v12 offset:2240
  ds_read_b128 v[60:63], v12 offset:2304
  s_waitcnt lgkmcnt(11)
  v_mfma_f32_16x16x32_bf16 v[4:7], v[64:67], v[16:19], 0
  ds_read_b128 v[16:19], v12 offset:2368
  s_waitcnt lgkmcnt(11)
  v_mfma_f32_16x16x32_bf16 v[8:11], v[68:71], v[20:23], 0
  ds_read_b128 v[20:23], v12 offset:2432
  s_waitcnt lgkmcnt(11)
  v_mfma_f32_16x16x32_bf16 v[4:7], v[72:75], v[24:27], v[4:7]
  ds_read_b128 v[24:27], v12 offset:2496
  s_waitcnt lgkmcnt(11)
  v_mfma_f32_16x16x32_bf16 v[8:11], v[76:79], v[28:31], v[8:11]
  ds_read_b128 v[28:31], v12 offset:2560
  s_waitcnt lgkmcnt(11)
  v_mfma_f32_16x16x32_bf16 v[4:7], v[80:83], v[32:35], v[4:7]
  s_waitcnt lgkmcnt(10)
  v_mfma_f32_16x16x32_bf16 v[8:11], v[84:87], v[36:39], v[8:11]
  s_waitcnt lgkmcnt(9)
  v_mfma_f32_16x16x32_bf16 v[4:7], v[88:91], v[40:43], v[4:7]
  s_waitcnt lgkmcnt(8)
  v_mfma_f32_16x16x32_bf16 v[8:11], v[92:95], v[44:47], v[8:11]
  s_waitcnt lgkmcnt(7)
  v_mfma_f32_16x16x32_bf16 v[4:7], v[96:99], v[48:51], v[4:7]
  s_waitcnt lgkmcnt(6)
  v_mfma_f32_16x16x32_bf16 v[8:11], v[100:103], v[52:55], v[8:11]
  s_waitcnt lgkmcnt(5)
  v_mfma_f32_16x16x32_bf16 v[4:7], v[104:107], v[56:59], v[4:7]
  s_waitcnt lgkmcnt(4)
  v_mfma_f32_16x16x32_bf16 v[8:11], v[108:111], v[60:63], v[8:11]
  s_waitcnt lgkmcnt(3)
  v_mfma_f32_16x16x32_bf16 v[4:7], v[112:115], v[16:19], v[4:7]
  s_waitcnt lgkmcnt(2)
  v_mfma_f32_16x16x32_bf16 v[8:11], v[116:119], v[20:23], v[8:11]
  s_waitcnt lgkmcnt(1)
  v_mfma_f32_16x16x32_bf16 v[4:7], v[120:123], v[24:27], v[4:7]
  s_waitcnt lgkmcnt(0)
  v_mfma_f32_16x16x32_bf16 v[8:11], v[124:127], v[28:31], v[8:11]
  v_lshlrev_b32 v14, 5, v3
  s_lshl_b32 s14, s4, 2
  v_add_u32 v15, s14, v14
  s_nop 4
  v_pk_add_f32 v[4:5], v[4:5], v[8:9]
  v_pk_add_f32 v[6:7], v[6:7], v[10:11]
  v_max3_f32 v12, v4, v5, v6
  v_max_f32 v12, v12, v7
  v_mov_b32 v13, v12
  s_nop 1
  v_permlane32_swap_b32 v12, v13
  v_max_f32 v12, v12, v13
  v_mov_b32 v13, v12
  s_nop 1
  v_permlane16_swap_b32 v12, v13
  v_max_f32 v12, v12, v13
  ds_write_b32 v15, v12 offset:18496
  s_nop 0
A_B2:
  s_waitcnt lgkmcnt(0)
  s_barrier
  s_cmp_ge_u32 s4, 8
  s_cbranch_scc1 A_B3
  ds_read_b128 v[16:19], v14 offset:18496
  ds_read_b128 v[20:23], v14 offset:18512
  v_lshlrev_b32 v13, 7, v3
  v_lshl_add_u32 v13, v2, 2, v13
  s_lshl_b32 s14, s4, 4
  v_add_u32 v13, s14, v13
  v_mul_u32_u24 v15, 288, v3
  v_lshl_add_u32 v15, v2, 4, v15
  s_lshr_b32 s14, s4, 1
  s_lshl_b32 s14, s14, 6
  s_and_b32 s15, s4, 1
  s_lshl_b32 s15, s15, 3
  s_add_u32 s14, s14, s15
  v_add_u32 v15, s14, v15
  s_waitcnt lgkmcnt(0)
  v_max3_f32 v12, v16, v17, v18
  v_max3_f32 v12, v12, v19, v20
  v_max3_f32 v12, v12, v21, v22
  v_max_f32 v12, v12, v23
  v_sub_f32 v4, v4, v12
  v_sub_f32 v5, v5, v12
  v_sub_f32 v6, v6, v12
  v_sub_f32 v7, v7, v12
  v_exp_f32 v4, v4
  v_exp_f32 v5, v5
  v_exp_f32 v6, v6
  v_exp_f32 v7, v7
  v_cvt_pk_bf16_f32 v8, v4, v5
  v_cvt_pk_bf16_f32 v9, v6, v7
  ds_write_b64 v15, v[8:9] offset:19008
  v_add_f32 v4, v4, v5
  v_add_f32 v6, v6, v7
  v_add_f32 v4, v4, v6
  ds_write_b32 v13, v4 offset:23616
  s_nop 0
A_B3:
  s_waitcnt lgkmcnt(0)
  s_barrier
  s_cmp_lt_u32 s4, 8
  s_cbranch_scc1 A_STAT
  ds_read_b128 v[16:19], v15 offset:19008
  ds_read_b128 v[20:23], v15 offset:19072
  ds_read_b128 v[24:27], v15 offset:19136
  ds_read_b128 v[28:31], v15 offset:19200
  s_waitcnt lgkmcnt(3)
  v_mfma_f32_16x16x32_bf16 v[32:35], v[64:67], v[16:19], 0
  v_mfma_f32_16x16x32_bf16 v[36:39], v[80:83], v[16:19], 0
  v_mfma_f32_16x16x32_bf16 v[40:43], v[96:99], v[16:19], 0
  v_mfma_f32_16x16x32_bf16 v[44:47], v[112:115], v[16:19], 0
  s_waitcnt lgkmcnt(2)
  v_mfma_f32_16x16x32_bf16 v[32:35], v[68:71], v[20:23], v[32:35]
  v_mfma_f32_16x16x32_bf16 v[36:39], v[84:87], v[20:23], v[36:39]
  v_mfma_f32_16x16x32_bf16 v[40:43], v[100:103], v[20:23], v[40:43]
  v_mfma_f32_16x16x32_bf16 v[44:47], v[116:119], v[20:23], v[44:47]
  s_waitcnt lgkmcnt(1)
  v_mfma_f32_16x16x32_bf16 v[32:35], v[72:75], v[24:27], v[32:35]
  v_mfma_f32_16x16x32_bf16 v[36:39], v[88:91], v[24:27], v[36:39]
  v_mfma_f32_16x16x32_bf16 v[40:43], v[104:107], v[24:27], v[40:43]
  v_mfma_f32_16x16x32_bf16 v[44:47], v[120:123], v[24:27], v[44:47]
  s_waitcnt lgkmcnt(0)
  v_mfma_f32_16x16x32_bf16 v[32:35], v[76:79], v[28:31], v[32:35]
  v_mfma_f32_16x16x32_bf16 v[36:39], v[92:95], v[28:31], v[36:39]
  v_mfma_f32_16x16x32_bf16 v[40:43], v[108:111], v[28:31], v[40:43]
  v_mfma_f32_16x16x32_bf16 v[44:47], v[124:127], v[28:31], v[44:47]
  s_nop 4
  v_cvt_pk_bf16_f32 v16, v32, v33
  v_cvt_pk_bf16_f32 v17, v34, v35
  v_cvt_pk_bf16_f32 v18, v36, v37
  v_cvt_pk_bf16_f32 v19, v38, v39
  v_cvt_pk_bf16_f32 v20, v40, v41
  v_cvt_pk_bf16_f32 v21, v42, v43
  v_cvt_pk_bf16_f32 v22, v44, v45
  v_cvt_pk_bf16_f32 v23, v46, v47
  v_mov_b32 v24, v16
  v_mov_b32 v25, v17
  v_mov_b32 v26, v18
  v_mov_b32 v27, v19
  v_mov_b32_dpp v16, v20 row_ror:8 row_mask:0xf bank_mask:0xc
  v_mov_b32_dpp v17, v21 row_ror:8 row_mask:0xf bank_mask:0xc
  v_mov_b32_dpp v18, v22 row_ror:8 row_mask:0xf bank_mask:0xc
  v_mov_b32_dpp v19, v23 row_ror:8 row_mask:0xf bank_mask:0xc
  buffer_store_dwordx4 v[16:19], v4, s[60:63], s11 offen offset:0 sc1
  v_mov_b32_dpp v20, v24 row_ror:8 row_mask:0xf bank_mask:0x3
  v_mov_b32_dpp v21, v25 row_ror:8 row_mask:0xf bank_mask:0x3
  v_mov_b32_dpp v22, v26 row_ror:8 row_mask:0xf bank_mask:0x3
  v_mov_b32_dpp v23, v27 row_ror:8 row_mask:0xf bank_mask:0x3
  buffer_store_dwordx4 v[20:23], v5, s[60:63], s11 offen offset:0 sc1
  s_nop 1
  s_branch A_POST
A_STAT:
  s_cmp_lg_u32 s4, 0
  s_cbranch_scc1 A_POST
  v_lshlrev_b32 v13, 7, v3
  v_lshl_add_u32 v13, v2, 5, v13
  ds_read_b128 v[16:19], v13 offset:23616
  ds_read_b128 v[20:23], v13 offset:23632
  s_lshl_b32 s14, s9, 17
  s_lshl_b32 s15, s8, 7
  s_add_u32 s14, s14, s15
  s_add_u32 s14, s14, 786432
  v_lshl_add_u32 v4, v3, 13, s14
  v_mov_b32 v13, s7
  v_mov_b32 v15, s7
  s_waitcnt lgkmcnt(0)
  v_pk_add_f32 v[16:17], v[16:17], v[18:19]
  v_pk_add_f32 v[20:21], v[20:21], v[22:23]
  v_pk_add_f32 v[16:17], v[16:17], v[20:21]
  v_add_f32 v14, v16, v17
  v_mov_b32 v16, v14
  s_nop 1
  v_permlane32_swap_b32 v14, v16
  v_add_f32 v14, v14, v16
  v_mov_b32 v16, v14
  s_nop 1
  v_permlane16_swap_b32 v14, v16
  v_add_f32 v14, v14, v16
  s_mov_b64 exec, 0xffff
  buffer_store_dwordx4 v[12:15], v4, s[60:63], s11 offen offset:0 sc1
  s_mov_b64 exec, -1
  s_nop 0
A_POST:
  s_barrier
  s_cmp_lg_u32 s58, 0
  s_cbranch_scc1 A_P2
  v_mov_b32 v8, -1
  v_mov_b32 v9, -1
  v_mov_b32 v10, -1
  v_mov_b32 v11, -1
  s_cmp_lt_u32 s10, 54
  s_nop 0
  s_cbranch_scc1 A_P2
  s_lshl_b32 s14, s9, 4
  s_add_u32 s14, s14, s4
  s_lshl_b32 s14, s14, 16
  s_lshl_b32 s15, s8, 8
  s_add_u32 s14, s14, s15
  s_add_u32 s14, s14, 1048576
  v_lshlrev_b32 v6, 14, v2
  v_lshl_add_u32 v6, v3, 4, v6
  v_add_u32 v6, s14, v6
  buffer_store_dwordx4 v[8:11], v6, s[60:63], s3 offen sc1
  s_nop 1
A_P2:
  s_cmp_ge_u32 s10, 54
  s_cbranch_scc1 A_NEXT
  s_cmp_lg_u32 s58, 0
  s_cbranch_scc1 F_POLL
  s_mov_b32 s64, s46
  s_mov_b32 s65, s47
  s_mov_b32 s66, 2211840
  s_mov_b32 s67, 0x00020000
  s_mov_b32 s68, s48
  s_mov_b32 s69, s49
  s_mov_b32 s70, 2211840
  s_mov_b32 s71, 0x00020000
  s_mov_b32 s72, s50
  s_mov_b32 s73, s51
  s_mov_b32 s74, 2211840
  s_mov_b32 s75, 0x00020000
  v_lshrrev_b32 v4, 2, v1
  v_mul_u32_u24 v4, 3456, v4
  v_lshrrev_b32 v5, 5, v1
  v_lshlrev_b32 v5, 1, v5
  v_and_b32 v6, 3, v1
  v_xor_b32 v5, v5, v6
  v_lshl_add_u32 v4, v5, 4, v4
  v_mul_u32_u24 v5, 1280, v2
  s_bfe_u32 s14, s4, 0x10001
  s_lshl_b32 s14, s14, 3
  v_lshl_or_b32 v6, v2, 1, s14
  v_xor_b32 v6, v6, v3
  v_lshl_add_u32 v5, v6, 4, v5
  s_and_b32 s18, s4, 7
  s_mul_i32 s14, s18, 55296
  s_lshl_b32 s15, s10, 6
  s_add_u32 s14, s14, s15
  s_lshl_b32 s15, s18, 10
  s_mul_i32 s16, s10, 40960
  s_mul_i32 s17, s18, 5120
  s_add_u32 s16, s16, s17
  s_cmp_lt_u32 s4, 8
  s_cbranch_scc1 F_CLR
  s_add_u32 s18, s14, 884736
  s_add_u32 s17, s15, 57344
  s_mov_b32 m0, s17
  s_nop 0
  buffer_load_dwordx4 v4, s[64:67], s18 offen nt lds
  s_add_u32 s17, s15, 98304
  s_mov_b32 m0, s17
  s_nop 0
  buffer_load_dwordx4 v4, s[68:71], s18 offen nt lds
  s_add_u32 s18, s14, 1327104
  s_add_u32 s17, s15, 65536
  s_mov_b32 m0, s17
  s_nop 0
  buffer_load_dwordx4 v4, s[64:67], s18 offen nt lds
  s_add_u32 s17, s15, 106496
  s_mov_b32 m0, s17
  s_nop 0
  buffer_load_dwordx4 v4, s[68:71], s18 offen nt lds
  s_add_u32 s18, s14, 1769472
  s_add_u32 s17, s15, 73728
  s_mov_b32 m0, s17
  s_nop 0
  buffer_load_dwordx4 v4, s[64:67], s18 offen nt lds
  s_add_u32 s17, s15, 114688
  s_mov_b32 m0, s17
  s_nop 0
  buffer_load_dwordx4 v4, s[68:71], s18 offen nt lds
F_CLR:
  s_lshl_b32 s14, s9, 4
  s_add_u32 s14, s14, s4
  s_lshl_b32 s14, s14, 16
  s_lshl_b32 s15, s8, 8
  s_add_u32 s14, s14, s15
  s_add_u32 s14, s14, 1048576
  v_lshlrev_b32 v6, 14, v2
  v_lshl_add_u32 v6, v3, 4, v6
  v_add_u32 v6, s14, v6
  buffer_store_dwordx4 v[8:11], v6, s[60:63], s3 offen sc1
  s_nop 1
F_POLL:
  s_waitcnt vmcnt(1)
  s_barrier
  s_and_b32 s15, s4, 3
  s_bfe_u32 s16, s4, 0x10002
  s_lshr_b32 s17, s4, 3
  s_mul_i32 s17, s17, 40960
  s_mul_i32 s18, s15, 10240
  s_add_u32 s17, s17, s18
  s_add_u32 s17, s17, 40960
  v_lshrrev_b32 v12, 2, v3
  v_lshl_add_u32 v12, v2, 3, v12
  v_lshlrev_b32 v12, 6, v12
  v_and_b32 v13, 1, v2
  v_xor_b32 v13, s16, v13
  v_lshl_add_u32 v12, v13, 5, v12
  v_and_b32 v13, 3, v1
  v_lshl_add_u32 v12, v13, 3, v12
  v_add_u32 v12, s17, v12
  ds_read_b64_tr_b16 v[44:45], v12 offset:0
  ds_read_b64_tr_b16 v[46:47], v12 offset:256
  ds_read_b64_tr_b16 v[48:49], v12 offset:2048
  ds_read_b64_tr_b16 v[50:51], v12 offset:2304
  ds_read_b64_tr_b16 v[52:53], v12 offset:4096
  ds_read_b64_tr_b16 v[54:55], v12 offset:4352
  ds_read_b64_tr_b16 v[56:57], v12 offset:6144
  ds_read_b64_tr_b16 v[58:59], v12 offset:6400
  ds_read_b64_tr_b16 v[60:61], v12 offset:8192
  ds_read_b64_tr_b16 v[62:63], v12 offset:8448
  s_mul_i32 s14, s15, 320
  s_add_u32 s14, s14, 0
  v_mov_b32 v24, 1280
  v_mov_b32 v25, s14
  v_cmp_eq_u32 vcc, 0, v3
  s_nop 1
  v_cndmask_b32 v24, v24, v25, vcc
  v_lshl_add_u32 v24, v2, 4, v24
  s_min_u32 s14, s4, 9
  s_lshr_b32 s16, s14, 1
  s_lshl_b32 s16, s16, 13
  s_add_u32 s16, s16, 122880
  s_and_b32 s14, s14, 1
  s_lshl_b32 s14, s14, 3
  v_lshrrev_b32 v12, 2, v3
  v_and_b32 v13, 1, v2
  v_lshl_add_u32 v13, v13, 2, v12
  v_lshl_add_u32 v12, v2, 3, v12
  v_lshlrev_b32 v12, 8, v12
  v_and_b32 v14, 3, v1
  v_or_b32 v14, s14, v14
  v_lshlrev_b32 v13, 1, v13
  v_xor_b32 v13, v13, v14
  v_lshl_add_u32 v12, v13, 4, v12
  v_add_u32 v25, s16, v12
  v_xor_b32 v26, 64, v25
  s_lshl_b32 s14, s4, 7
  v_lshlrev_b32 v14, 6, v3
  v_lshl_add_u32 v14, v2, 4, v14
  v_add_u32 v27, s14, v14
  s_mul_i32 s15, s10, 1280
  s_add_u32 s14, s14, s15
  s_add_u32 s14, s14, 393216
  v_add_u32 v31, s14, v14
  v_lshlrev_b32 v28, 9, v2
  v_lshl_add_u32 v28, v3, 2, v28
  v_add_u32 v28, 25856, v28
  s_lshl_b32 s14, s4, 6
  v_and_b32 v29, 31, v1
  v_lshl_add_u32 v29, v29, 1, s14
  v_lshl_add_u32 v30, v2, 4, s14
  v_lshrrev_b32 v40, 3, v1
  v_and_b32 v41, 7, v1
  v_mul_u32_u24 v42, 1280, v40
  s_lshl_b32 s14, s4, 7
  s_add_u32 s15, s14, 327680
  v_lshl_add_u32 v42, v41, 4, v42
  v_add_u32 v42, s15, v42
  v_cmp_gt_u32 vcc, 1, v40
  v_mov_b32 v43, 0x7ff00000
  s_add_u32 s16, s11, 10240
  v_cndmask_b32 v43, v43, v42, vcc
  v_lshlrev_b32 v41, 4, v41
  v_lshl_add_u32 v41, v2, 2, v41
  v_add_u32 v41, s14, v41
  s_movk_i32 s24, 0x3f80
  s_mov_b32 s25, 0x3f800000
  s_add_u32 s17, s11, 20480
  s_add_u32 s18, s11, 30720
  s_add_u32 s19, s11, 40960
  s_cmp_lg_u32 s4, 0
  s_cbranch_scc1 F_SC
  v_lshlrev_b32 v18, 7, v1
  v_add_u32 v19, 24576, v18
  v_add_u32 v18, 16384, v18
  s_nop 1
POLL_5:
  buffer_load_dwordx4 v[8:11], v18, s[60:63], s11 offen offset:0 sc1
  buffer_load_dwordx4 v[20:23], v19, s[60:63], s11 offen offset:0 sc1
  s_waitcnt vmcnt(1)
  v_xor_b32 v14, s7, v9
  v_xor_b32 v13, s7, v11
  v_or_b32 v14, v14, v13
  s_waitcnt vmcnt(0)
  v_xor_b32 v13, s7, v21
  v_or_b32 v14, v14, v13
  v_xor_b32 v13, s7, v23
  v_or_b32 v14, v14, v13
  v_cmp_ne_u32 vcc, 0, v14
  s_nop 4
  s_cbranch_vccz PDONE_6
  s_sub_u32 s12, s12, 1
  s_cbranch_scc0 POLL_5
  s_mov_b32 s12, 0
PDONE_6:
F_SC:
  s_barrier
  s_cmp_ge_u32 s4, 10
  s_cbranch_scc1 F_B1
CONS_7:
  buffer_load_dwordx4 v[4:7], v42, s[60:63], s11 offen sc1
  buffer_load_dwordx4 v[8:11], v42, s[60:63], s16 offen sc1
  buffer_load_dwordx4 v[12:15], v42, s[60:63], s17 offen sc1
  buffer_load_dwordx4 v[16:19], v42, s[60:63], s18 offen sc1
  buffer_load_dwordx4 v[20:23], v43, s[60:63], s19 offen sc1
  s_waitcnt vmcnt(4)
  v_max3_u32 v40, v4, v5, v6
  v_max_u32 v40, v40, v7
  v_dot2_f32_bf16 v32, s24, v4, 0
  v_dot2_f32_bf16 v33, s25, v4, 0
  v_dot2_f32_bf16 v34, s24, v5, 0
  v_dot2_f32_bf16 v35, s25, v5, 0
  v_dot2_f32_bf16 v36, s24, v6, 0
  v_dot2_f32_bf16 v37, s25, v6, 0
  v_dot2_f32_bf16 v38, s24, v7, 0
  v_dot2_f32_bf16 v39, s25, v7, 0
  s_waitcnt vmcnt(3)
  v_max3_u32 v40, v40, v8, v9
  v_max3_u32 v40, v40, v10, v11
  v_dot2c_f32_bf16 v32, s24, v8
  v_dot2c_f32_bf16 v33, s25, v8
  v_dot2c_f32_bf16 v34, s24, v9
  v_dot2c_f32_bf16 v35, s25, v9
  v_dot2c_f32_bf16 v36, s24, v10
  v_dot2c_f32_bf16 v37, s25, v10
  v_dot2c_f32_bf16 v38, s24, v11
  v_dot2c_f32_bf16 v39, s25, v11
  s_waitcnt vmcnt(2)
  v_max3_u32 v40, v40, v12, v13
  v_max3_u32 v40, v40, v14, v15
  v_dot2c_f32_bf16 v32, s24, v12
  v_dot2c_f32_bf16 v33, s25, v12
  v_dot2c_f32_bf16 v34, s24, v13
  v_dot2c_f32_bf16 v35, s25, v13
  v_dot2c_f32_bf16 v36, s24, v14
  v_dot2c_f32_bf16 v37, s25, v14
  v_dot2c_f32_bf16 v38, s24, v15
  v_dot2c_f32_bf16 v39, s25, v15
  s_waitcnt vmcnt(1)
  v_max3_u32 v40, v40, v16, v17
  v_max3_u32 v40, v40, v18, v19
  v_dot2c_f32_bf16 v32, s24, v16
  v_dot2c_f32_bf16 v33, s25, v16
  v_dot2c_f32_bf16 v34, s24, v17
  v_dot2c_f32_bf16 v35, s25, v17
  v_dot2c_f32_bf16 v36, s24, v18
  v_dot2c_f32_bf16 v37, s25, v18
  v_dot2c_f32_bf16 v38, s24, v19
  v_dot2c_f32_bf16 v39, s25, v19
  s_waitcnt vmcnt(0)
  v_max3_u32 v40, v40, v20, v21
  v_max3_u32 v40, v40, v22, v23
  v_dot2c_f32_bf16 v32, s24, v20
  v_dot2c_f32_bf16 v33, s25, v20
  v_dot2c_f32_bf16 v34, s24, v21
  v_dot2c_f32_bf16 v35, s25, v21
  v_dot2c_f32_bf16 v36, s24, v22
  v_dot2c_f32_bf16 v37, s25, v22
  v_dot2c_f32_bf16 v38, s24, v23
  v_dot2c_f32_bf16 v39, s25, v23
  v_cmp_eq_u32 vcc, -1, v40
  s_nop 4
  s_cbranch_vccz CDONE_8
  s_sub_u32 s12, s12, 1
  s_cbranch_scc0 CONS_7
  s_mov_b32 s12, 0
CDONE_8:
  v_permlane32_swap_b32 v32, v36
  v_permlane32_swap_b32 v33, v37
  v_permlane32_swap_b32 v34, v38
  v_permlane32_swap_b32 v35, v39
  v_add_f32 v32, v32, v36
  v_add_f32 v33, v33, v37
  v_add_f32 v34, v34, v38
  v_add_f32 v35, v35, v39
  s_nop 0
  v_permlane16_swap_b32 v32, v34
  v_permlane16_swap_b32 v33, v35
  v_add_f32 v32, v32, v34
  v_add_f32 v33, v33, v35
  s_nop 0
  v_add_f32_dpp v32, v32, v32 row_ror:8 row_mask:0xf bank_mask:0xf
  v_add_f32_dpp v33, v33, v33 row_ror:8 row_mask:0xf bank_mask:0xf
  v_cvt_pk_bf16_f32 v32, v32, v33
  ds_write_b32 v41, v32 offset:0
  s_nop 0
F_B1:
  s_waitcnt lgkmcnt(0)
  s_barrier
  ds_read_b128 v[4:7], v24 offset:0
  ds_read_b128 v[8:11], v24 offset:64
  ds_read_b128 v[12:15], v24 offset:128
  ds_read_b128 v[16:19], v24 offset:192
  ds_read_b128 v[20:23], v24 offset:256
  s_movk_i32 s14, 0x8421
  s_lshr_b32 s14, s14, s4
  s_bitcmp1_b32 s14, 0
  s_cbranch_scc1 F_S5S
  s_waitcnt lgkmcnt(4)
  v_mfma_f32_16x16x32_bf16 v[32:35], v[44:47], v[4:7], 0
  s_waitcnt lgkmcnt(3)
  v_mfma_f32_16x16x32_bf16 v[32:35], v[48:51], v[8:11], v[32:35]
  s_waitcnt lgkmcnt(2)
  v_mfma_f32_16x16x32_bf16 v[32:35], v[52:55], v[12:15], v[32:35]
  s_waitcnt lgkmcnt(1)
  v_mfma_f32_16x16x32_bf16 v[32:35], v[56:59], v[16:19], v[32:35]
  s_waitcnt lgkmcnt(0)
  v_mfma_f32_16x16x32_bf16 v[32:35], v[60:63], v[20:23], v[32:35]
  ds_read_b64_tr_b16 v[4:5], v25 offset:0
  ds_read_b64_tr_b16 v[6:7], v25 offset:1024
  ds_read_b64_tr_b16 v[8:9], v25 offset:8
  ds_read_b64_tr_b16 v[10:11], v25 offset:1032
  ds_read_b64_tr_b16 v[12:13], v26 offset:0
  ds_read_b64_tr_b16 v[14:15], v26 offset:1024
  ds_read_b64_tr_b16 v[16:17], v26 offset:8
  ds_read_b64_tr_b16 v[18:19], v26 offset:1032
  s_mov_b64 exec, s[76:77]
  ds_write_b128 v27, v[32:35] offset:25856
  s_mov_b64 exec, -1
  s_branch F_S5E
F_S5S:
  s_waitcnt lgkmcnt(4)
  v_mfma_f32_16x16x32_bf16 v[32:35], v[44:47], v[4:7], 0
  v_mfma_f32_16x16x32_bf16 v[36:39], v[4:7], v[4:7], 0
  s_waitcnt lgkmcnt(3)
  v_mfma_f32_16x16x32_bf16 v[32:35], v[48:51], v[8:11], v[32:35]
  v_mfma_f32_16x16x32_bf16 v[36:39], v[8:11], v[8:11], v[36:39]
  s_waitcnt lgkmcnt(2)
  v_mfma_f32_16x16x32_bf16 v[32:35], v[52:55], v[12:15], v[32:35]
  v_mfma_f32_16x16x32_bf16 v[36:39], v[12:15], v[12:15], v[36:39]
  s_waitcnt lgkmcnt(1)
  v_mfma_f32_16x16x32_bf16 v[32:35], v[56:59], v[16:19], v[32:35]
  v_mfma_f32_16x16x32_bf16 v[36:39], v[16:19], v[16:19], v[36:39]
  s_waitcnt lgkmcnt(0)
  v_mfma_f32_16x16x32_bf16 v[32:35], v[60:63], v[20:23], v[32:35]
  v_mfma_f32_16x16x32_bf16 v[36:39], v[20:23], v[20:23], v[36:39]
  ds_read_b64_tr_b16 v[4:5], v25 offset:0
  ds_read_b64_tr_b16 v[6:7], v25 offset:1024
  ds_read_b64_tr_b16 v[8:9], v25 offset:8
  ds_read_b64_tr_b16 v[10:11], v25 offset:1032
  ds_read_b64_tr_b16 v[12:13], v26 offset:0
  ds_read_b64_tr_b16 v[14:15], v26 offset:1024
  ds_read_b64_tr_b16 v[16:17], v26 offset:8
  ds_read_b64_tr_b16 v[18:19], v26 offset:1032
  s_and_b32 s14, s4, 3
  s_lshl_b32 s14, s14, 3
  v_mov_b32 v40, s14
  s_mov_b64 exec, 1
  ds_write_b64 v40, v[36:37] offset:25664
  s_mov_b64 exec, s[76:77]
  ds_write_b128 v27, v[32:35] offset:25856
  s_mov_b64 exec, -1
F_S5E:
  s_waitcnt lgkmcnt(0)
  s_barrier
  s_cmp_lt_u32 s4, 10
  s_cbranch_scc1 F_S6
  s_cmp_lg_u32 s4, 10
  s_cbranch_scc1 F_XP
  s_lshl_b32 s14, s10, 7
  s_add_u32 s14, s14, 32768
  v_mov_b32 v4, s14
  v_mov_b32 v9, s7
  v_mov_b32 v11, s7
  s_mov_b64 exec, 1
  buffer_store_dwordx4 v[8:11], v4, s[60:63], s11 offen offset:0 sc1
  s_mov_b64 exec, -1
  s_nop 0
  s_branch F_END
F_XP:
  s_cmp_lg_u32 s10, 0
  s_cbranch_scc1 F_END
  s_cmp_lt_u32 s4, 14
  s_cbranch_scc1 F_END
  s_sub_u32 s14, s4, 14
  s_lshl_b32 s14, s14, 6
  v_add_u32 v4, s14, v1
  v_cmp_gt_u32 vcc, 80, v4
  s_nop 0
  s_and_saveexec_b64 s[26:27], vcc
  s_nop 2
  s_cbranch_execz F_XR_x
  v_lshlrev_b32 v4, 4, v4
  v_add_u32 v5, 0, v4
  v_add_u32 v4, 462336, v4
  ds_read_b128 v[8:11], v5 offset:0
  s_waitcnt lgkmcnt(0)
  buffer_store_dwordx4 v[8:11], v4, s[60:63], s11 offen offset:0 sc1
  s_nop 1
F_XR_x:
  s_mov_b64 exec, -1
  s_branch F_END
F_S6:
  v_mov_b32 v24, 0
  ds_read2_b32 v[32:33], v28 offset0:0 offset1:16
  ds_read2_b32 v[34:35], v28 offset0:32 offset1:48
  ds_read2_b32 v[36:37], v28 offset0:64 offset1:80
  ds_read2_b32 v[38:39], v28 offset0:96 offset1:112
  ds_read_b128 v[40:43], v24 offset:25664
  ds_read_b128 v[44:47], v24 offset:25680
  s_waitcnt lgkmcnt(0)
  v_pk_add_f32 v[40:41], v[40:41], v[42:43]
  v_pk_add_f32 v[44:45], v[44:45], v[46:47]
  v_pk_add_f32 v[32:33], v[32:33], v[34:35]
  v_pk_add_f32 v[40:41], v[40:41], v[44:45]
  v_pk_add_f32 v[36:37], v[36:37], v[38:39]
  v_pk_add_f32 v[32:33], v[32:33], v[36:37]
  v_mul_f32 v41, 1.562500000000e-03, v41
  v_mul_f32 v40, 1.562500000000e-03, v40
  v_fma_f32 v42, -v41, v41, v40
  v_max_f32 v42, 0, v42
  v_add_f32 v42, 1.0e-5, v42
  v_rsq_f32 v40, v42
  v_fma_f32 v32, -v41, v33, v32
  v_mul_f32 v32, v32, v40
  v_cvt_pk_bf16_f32 v32, v32, v32
  v_and_b32 v32, 0xffff0000, v32
  v_mov_b32 v33, v32
  s_nop 1
  v_permlane32_swap_b32 v32, v33
  v_mul_f32 v34, v32, v32
  v_mov_b32 v35, 1.0
  v_fmac_f32 v35, 0.044715, v34
  v_mul_f32 v35, v35, v32
  v_mul_f32 v35, -2.302208198, v35
  v_exp_f32 v35, v35
  s_nop 0
  v_add_f32 v35, 1.0, v35
  v_rcp_f32 v35, v35
  s_nop 0
  v_mul_f32 v32, v32, v35
  v_cvt_pk_bf16_f32 v32, v32, v32
  v_and_b32 v32, 0xffff0000, v32
  v_mul_f32 v32, v32, v33
  v_cvt_pk_bf16_f32 v32, v32, v32
  ds_write_b16 v29, v32 offset:27904
  ds_read_b128 v[20:23], v30 offset:27904
  v_cmp_eq_u32 vcc, 1, v3
  s_waitcnt lgkmcnt(0)
  v_mfma_f32_16x16x32_bf16 v[32:35], v[4:7], v[20:23], 0
  v_mfma_f32_16x16x32_bf16 v[36:39], v[8:11], v[20:23], 0
  v_mfma_f32_16x16x32_bf16 v[40:43], v[12:15], v[20:23], 0
  v_mfma_f32_16x16x32_bf16 v[44:47], v[16:19], v[20:23], 0
  s_nop 4
  v_cvt_pk_bf16_f32 v16, v32, v33
  v_cvt_pk_bf16_f32 v17, v34, v35
  v_cvt_pk_bf16_f32 v18, v36, v37
  v_cvt_pk_bf16_f32 v19, v38, v39
  v_cvt_pk_bf16_f32 v20, v40, v41
  v_cvt_pk_bf16_f32 v21, v42, v43
  v_cvt_pk_bf16_f32 v22, v44, v45
  v_cvt_pk_bf16_f32 v23, v46, v47
  v_cndmask_b32 v16, v16, v20, vcc
  v_cndmask_b32 v17, v17, v21, vcc
  v_cndmask_b32 v18, v18, v22, vcc
  v_cndmask_b32 v19, v19, v23, vcc
  s_mov_b64 exec, s[76:77]
  buffer_store_dwordx4 v[16:19], v31, s[60:63], s11 offen offset:0 sc1
  s_mov_b64 exec, -1
  s_nop 0
F_END:
  s_barrier
A_NEXT:
  s_cmp_lg_u32 s58, 0
  s_cbranch_scc1 END
  s_mov_b32 s58, 1
  s_mov_b32 s31, 64
  s_add_u32 s11, s11, 4194304
  s_add_u32 s13, s13, 4194304
  s_branch A_LOOP
PROLE:
  s_sub_u32 s14, s6, 16
  s_lshl_b32 s8, s5, 2
  s_lshr_b32 s15, s14, 2
  s_add_u32 s8, s8, s15
  s_and_b32 s9, s14, 3
  s_sub_u32 s10, s2, 128
  s_mov_b32 s59, 0
  s_mov_b32 s64, s36
  s_mov_b32 s65, s37
  s_mov_b32 s66, 5242880
  s_mov_b32 s67, 0x00020000
  s_mov_b32 s68, s38
  s_mov_b32 s69, s39
  s_mov_b32 s70, 4194304
  s_mov_b32 s71, 0x00020000
  s_mov_b32 s72, s32
  s_mov_b32 s73, s33
  s_mov_b32 s74, 1280
  s_mov_b32 s75, 0x00020000
  s_cmp_lt_u32 s4, 14
  s_cbranch_scc1 P_SCL
  s_lshl_b32 s17, s8, 2
  s_add_u32 s17, s17, s9
  s_lshl_b32 s16, s17, 8
  s_add_u32 s16, s16, 131072
  s_lshl_b32 s17, s17, 9
  s_add_u32 s17, s17, 262144
  s_cmp_eq_u32 s8, 0
  s_cselect_b32 s18, 32, s8
  s_cmp_eq_u32 s4, 14
  s_cselect_b32 s18, s8, s18
  s_cselect_b32 s17, s17, s16
  s_cselect_b32 s16, 31, 15
  s_mul_i32 s18, s18, 1280
  s_mul_i32 s19, s9, 320
  s_add_u32 s18, s18, s19
  s_add_u32 s18, s18, 327168
  v_and_b32 v6, s16, v1
  v_lshl_add_u32 v6, v6, 4, s17
  v_lshl_add_u32 v7, v1, 4, s18
  v_cmp_gt_u32 vcc, 32, v1
  s_nop 1
  v_cndmask_b32 v6, v7, v6, vcc
  v_mov_b32 v7, 0x7ff00000
  v_cmp_gt_u32 vcc, 52, v1
  s_nop 1
  v_cndmask_b32 v6, v7, v6, vcc
  buffer_store_dwordx4 v[8:11], v6, s[60:63], s11 offen sc1
  buffer_store_dwordx4 v[8:11], v6, s[60:63], s3 offen sc1
  s_cmp_lg_u32 s4, 14
  s_nop 0
  s_cbranch_scc1 P_SCL
  v_subrev_u32 v6, 0x10000, v6
  s_mov_b32 exec_hi, 0
  buffer_store_dwordx4 v[8:11], v6, s[60:63], s11 offen sc1
  buffer_store_dwordx4 v[8:11], v6, s[60:63], s3 offen sc1
  s_mov_b64 exec, -1
  s_nop 0
P_SCL:
  s_lshl_b32 s15, s8, 8
  s_sub_u32 s16, s4, 8
  s_cmp_ge_u32 s16, 4
  s_cbranch_scc1 P_NUK
  v_lshrrev_b32 v4, 2, v3
  v_lshlrev_b32 v4, 3, v4
  v_and_b32 v5, 3, v3
  v_add_u32 v4, v4, v5
  v_lshlrev_b32 v4, 13, v4
  v_lshl_add_u32 v4, v2, 4, v4
  v_add_u32 v5, 32768, v4
  s_lshl_b32 s14, s9, 20
  s_add_u32 s14, s14, s15
  s_lshl_b32 s16, s16, 18
  s_add_u32 s14, s14, s16
  buffer_load_dwordx4 v[64:67], v4, s[68:71], s14 offen offset:0 nt
  buffer_load_dwordx4 v[68:71], v4, s[68:71], s14 offen offset:64 nt
  buffer_load_dwordx4 v[72:75], v4, s[68:71], s14 offen offset:128 nt
  buffer_load_dwordx4 v[76:79], v4, s[68:71], s14 offen offset:192 nt
  buffer_load_dwordx4 v[80:83], v5, s[68:71], s14 offen offset:0 nt
  buffer_load_dwordx4 v[84:87], v5, s[68:71], s14 offen offset:64 nt
  buffer_load_dwordx4 v[88:91], v5, s[68:71], s14 offen offset:128 nt
  buffer_load_dwordx4 v[92:95], v5, s[68:71], s14 offen offset:192 nt
P_NUK:
  v_lshlrev_b32 v4, 13, v2
  s_bfe_u32 s14, s4, 0x10001
  s_lshl_b32 s14, s14, 3
  v_lshl_or_b32 v5, v2, 1, s14
  v_xor_b32 v5, v5, v3
  v_lshl_add_u32 v4, v5, 4, v4
  s_xor_b32 s15, s9, 0
  s_mul_i32 s15, s15, 1310720
  s_lshl_b32 s14, s8, 8
  s_add_u32 s15, s15, s14
  s_lshl_b32 s14, s4, 15
  s_add_u32 s14, s14, s15
  s_lshl_b32 s16, s4, 10
  s_add_u32 s16, s16, 8192
  s_mov_b32 m0, s16
  s_nop 0
  buffer_load_dwordx4 v4, s[64:67], s14 offen nt lds
  s_add_u32 s14, s14, 524288
  s_add_u32 s16, s16, 16384
  s_mov_b32 m0, s16
  s_nop 0
  buffer_load_dwordx4 v4, s[64:67], s14 offen nt lds
  s_add_u32 s14, s14, 524288
  s_add_u32 s16, s16, 16384
  s_cmp_ge_u32 s4, 8
  s_cbranch_scc1 P_X0
  s_mov_b32 m0, s16
  s_nop 0
  buffer_load_dwordx4 v4, s[64:67], s14 offen nt lds
  s_branch P_RDY
P_X0:
  s_sub_u32 s14, s4, 12
  s_cmp_ge_u32 s14, 2
  s_cbranch_scc1 P_RDY
  s_lshl_b32 s14, s14, 10
  v_lshl_add_u32 v4, v1, 4, s14
  buffer_load_dwordx4 v[12:15], v4, s[72:75], 0 offen
  v_cmp_gt_u32 vcc, 1280, v4
  s_waitcnt vmcnt(0)
  s_and_saveexec_b64 s[26:27], vcc
  ds_write_b128 v4, v[12:15] offset:0
  s_mov_b64 exec, -1
  s_nop 0
P_RDY:
  s_waitcnt vmcnt(0)
  v_lshrrev_b32 v12, 2, v3
  v_and_b32 v13, 1, v2
  v_lshl_add_u32 v13, v13, 2, v12
  s_and_b32 s14, s4, 7
  v_xor_b32 v13, s14, v13
  v_lshl_add_u32 v12, v2, 3, v12
  v_lshlrev_b32 v12, 8, v12
  v_lshl_add_u32 v12, v13, 5, v12
  v_and_b32 v13, 3, v1
  v_lshl_add_u32 v12, v13, 3, v12
  s_lshr_b32 s5, s4, 3
  s_mul_i32 s14, s5, 40960
  s_add_u32 s14, s14, 8192
  v_add_u32 v0, s14, v12
  s_lshl_b32 s5, s5, 1
  s_movk_i32 s14, 0xf0e0
  s_lshr_b32 s14, s14, s4
  s_and_b32 s6, s14, 1
  s_xor_b32 s15, s5, s9
  s_mul_i32 s14, s15, 320
  s_add_u32 s14, s14, 0
  v_mov_b32 v4, 1280
  v_mov_b32 v5, s14
  v_cmp_eq_u32 vcc, 0, v3
  s_nop 1
  v_cndmask_b32 v4, v4, v5, vcc
  v_lshl_add_u32 v4, v2, 4, v4
  s_and_b32 s15, s9, 1
  s_mul_i32 s15, s15, -640
  s_add_u32 s15, s15, 320
  v_mov_b32 v5, s15
  v_cndmask_b32 v5, 0, v5, vcc
  v_add_u32 v5, v5, v4
  s_lshl_b32 s14, s5, 9
  s_and_b32 s15, s4, 7
  s_lshl_b32 s15, s15, 6
  s_add_u32 s14, s14, s15
  v_lshlrev_b32 v6, 9, v3
  v_lshl_add_u32 v6, v2, 4, v6
  v_add_u32 v6, s14, v6
  s_cmp_eq_u32 s6, 0
  s_nop 0
  s_cbranch_scc1 P_R1
  v_mov_b32 v92, v4
  v_mov_b32 v93, v5
  v_mov_b32 v94, v6
  s_nop 1
P_R1:
  s_waitcnt lgkmcnt(0)
  s_mul_i32 s7, s7, 1664525
  s_add_u32 s7, s7, 1013904223
  s_barrier
  s_cmp_ge_u32 s4, 8
  s_cbranch_scc1 P_S0B
  ds_read_b64_tr_b16 v[24:25], v0 offset:0
  ds_read_b64_tr_b16 v[26:27], v0 offset:1024
  ds_read_b64_tr_b16 v[28:29], v0 offset:8192
  ds_read_b64_tr_b16 v[30:31], v0 offset:9216
  ds_read_b64_tr_b16 v[32:33], v0 offset:16384
  ds_read_b64_tr_b16 v[34:35], v0 offset:17408
  ds_read_b64_tr_b16 v[36:37], v0 offset:24576
  ds_read_b64_tr_b16 v[38:39], v0 offset:25600
  ds_read_b64_tr_b16 v[40:41], v0 offset:32768
  ds_read_b64_tr_b16 v[42:43], v0 offset:33792
  ds_read_b128 v[44:47], v4 offset:0
  ds_read_b128 v[48:51], v4 offset:64
  ds_read_b128 v[52:55], v4 offset:128
  ds_read_b128 v[56:59], v4 offset:192
  ds_read_b128 v[60:63], v4 offset:256
  s_lshl_b32 s14, s8, 2
  s_add_u32 s14, s14, s9
  s_lshl_b32 s14, s14, 10
  s_lshl_b32 s15, s4, 6
  s_add_u32 s14, s14, s15
  s_add_u32 s14, s14, 524288
  v_lshlrev_b32 v12, 9, v3
  v_lshl_add_u32 v12, v2, 4, v12
  v_add_u32 v12, s14, v12
  s_waitcnt lgkmcnt(4)
  v_mfma_f32_16x16x32_bf16 v[8:11], v[24:27], v[44:47], 0
  s_waitcnt lgkmcnt(3)
  v_mfma_f32_16x16x32_bf16 v[8:11], v[28:31], v[48:51], v[8:11]
  s_waitcnt lgkmcnt(2)
  v_mfma_f32_16x16x32_bf16 v[8:11], v[32:35], v[52:55], v[8:11]
  s_waitcnt lgkmcnt(1)
  v_mfma_f32_16x16x32_bf16 v[8:11], v[36:39], v[56:59], v[8:11]
  s_waitcnt lgkmcnt(0)
  v_mfma_f32_16x16x32_bf16 v[8:11], v[40:43], v[60:63], v[8:11]
  s_mov_b64 exec, s[76:77]
  s_add_u32 s16, s11, 0x20000
  s_add_u32 s17, s13, 0x8000
  s_nop 4
  v_add3_u32 v14, v8, v9, v10
  v_lshrrev_b32 v15, 2, v12
  v_add3_u32 v14, v14, v11, s7
  buffer_store_dwordx4 v[8:11], v12, s[60:63], s16 offen offset:0
  buffer_store_dword v14, v15, s[60:63], s17 offen offset:0
  buffer_store_dwordx4 v[8:11], v12, s[60:63], s11 offen offset:0 sc1
  buffer_store_dword v14, v15, s[60:63], s13 offen offset:0 sc1
  s_mov_b64 exec, -1
  s_barrier
  s_branch P_XR
P_S0B:
  s_cmp_ge_u32 s4, 12
  s_cbranch_scc1 P_S0C
  s_mul_i32 s14, 0, 320
  s_add_u32 s14, s14, 0
  v_mov_b32 v4, 1280
  v_mov_b32 v5, s14
  v_cmp_eq_u32 vcc, 0, v3
  s_nop 1
  v_cndmask_b32 v4, v4, v5, vcc
  v_lshl_add_u32 v4, v2, 4, v4
  v_mov_b32 v5, 320
  v_cndmask_b32 v5, 0, v5, vcc
  ds_read_b128 v[12:15], v4 offset:0
  ds_read_b128 v[16:19], v4 offset:64
  ds_read_b128 v[20:23], v4 offset:128
  ds_read_b128 v[24:27], v4 offset:192
  ds_read_b128 v[28:31], v4 offset:256
  v_add_u32 v4, v4, v5
  ds_read_b128 v[32:35], v4 offset:0
  ds_read_b128 v[36:39], v4 offset:64
  ds_read_b128 v[40:43], v4 offset:128
  ds_read_b128 v[44:47], v4 offset:192
  ds_read_b128 v[48:51], v4 offset:256
  v_add_u32 v4, v4, v5
  s_waitcnt lgkmcnt(9)
  v_mfma_f32_16x16x32_bf16 v[8:11], v[12:15], v[12:15], 0
  s_waitcnt lgkmcnt(8)
  v_mfma_f32_16x16x32_bf16 v[8:11], v[16:19], v[16:19], v[8:11]
  s_waitcnt lgkmcnt(7)
  v_mfma_f32_16x16x32_bf16 v[8:11], v[20:23], v[20:23], v[8:11]
  s_waitcnt lgkmcnt(6)
  v_mfma_f32_16x16x32_bf16 v[8:11], v[24:27], v[24:27], v[8:11]
  s_waitcnt lgkmcnt(5)
  v_mfma_f32_16x16x32_bf16 v[8:11], v[28:31], v[28:31], v[8:11]
  ds_read_b128 v[12:15], v4 offset:0
  ds_read_b128 v[16:19], v4 offset:64
  ds_read_b128 v[20:23], v4 offset:128
  ds_read_b128 v[24:27], v4 offset:192
  ds_read_b128 v[28:31], v4 offset:256
  v_add_u32 v4, v4, v5
  s_waitcnt lgkmcnt(9)
  v_mfma_f32_16x16x32_bf16 v[8:11], v[32:35], v[32:35], v[8:11]
  s_waitcnt lgkmcnt(8)
  v_mfma_f32_16x16x32_bf16 v[8:11], v[36:39], v[36:39], v[8:11]
  s_waitcnt lgkmcnt(7)
  v_mfma_f32_16x16x32_bf16 v[8:11], v[40:43], v[40:43], v[8:11]
  s_waitcnt lgkmcnt(6)
  v_mfma_f32_16x16x32_bf16 v[8:11], v[44:47], v[44:47], v[8:11]
  s_waitcnt lgkmcnt(5)
  v_mfma_f32_16x16x32_bf16 v[8:11], v[48:51], v[48:51], v[8:11]
  ds_read_b128 v[32:35], v4 offset:0
  ds_read_b128 v[36:39], v4 offset:64
  ds_read_b128 v[40:43], v4 offset:128
  ds_read_b128 v[44:47], v4 offset:192
  ds_read_b128 v[48:51], v4 offset:256
  s_waitcnt lgkmcnt(9)
  v_mfma_f32_16x16x32_bf16 v[8:11], v[12:15], v[12:15], v[8:11]
  s_waitcnt lgkmcnt(8)
  v_mfma_f32_16x16x32_bf16 v[8:11], v[16:19], v[16:19], v[8:11]
  s_waitcnt lgkmcnt(7)
  v_mfma_f32_16x16x32_bf16 v[8:11], v[20:23], v[20:23], v[8:11]
  s_waitcnt lgkmcnt(6)
  v_mfma_f32_16x16x32_bf16 v[8:11], v[24:27], v[24:27], v[8:11]
  s_waitcnt lgkmcnt(5)
  v_mfma_f32_16x16x32_bf16 v[8:11], v[28:31], v[28:31], v[8:11]
  s_waitcnt lgkmcnt(4)
  v_mfma_f32_16x16x32_bf16 v[8:11], v[32:35], v[32:35], v[8:11]
  s_waitcnt lgkmcnt(3)
  v_mfma_f32_16x16x32_bf16 v[8:11], v[36:39], v[36:39], v[8:11]
  s_waitcnt lgkmcnt(2)
  v_mfma_f32_16x16x32_bf16 v[8:11], v[40:43], v[40:43], v[8:11]
  s_waitcnt lgkmcnt(1)
  v_mfma_f32_16x16x32_bf16 v[8:11], v[44:47], v[44:47], v[8:11]
  s_waitcnt lgkmcnt(0)
  v_mfma_f32_16x16x32_bf16 v[8:11], v[48:51], v[48:51], v[8:11]
  s_lshl_b32 s14, s8, 12
  s_add_u32 s14, s14, 524288
  v_lshl_add_u32 v4, v1, 4, s14
  v_lshrrev_b32 v5, 2, v4
  s_nop 3
  v_readfirstlane_b32 s14, v8
  v_readfirstlane_b32 s15, v9
  s_nop 0
  v_mov_b32 v32, s14
  v_mov_b32 v33, s15
  v_mul_f32 v33, 1.562500000000e-03, v33
  v_mul_f32 v32, 1.562500000000e-03, v32
  v_fma_f32 v34, -v33, v33, v32
  v_max_f32 v34, 0, v34
  v_add_f32 v34, 1.0e-5, v34
  v_rsq_f32 v32, v34
  s_add_u32 s16, s11, 0x20000
  s_add_u32 s17, s13, 0x8000
  s_mov_b32 s19, 0
  s_barrier
POLL_9:
  s_add_u32 s19, s19, 1
  s_and_b32 s18, s19, 7
  s_cselect_b32 s18, s16, s11
  s_cselect_b32 s15, s17, s13
  buffer_load_dword v28, v5, s[60:63], s15 offen offset:0 sc1
  buffer_load_dwordx4 v[12:15], v4, s[60:63], s18 offen offset:0 sc1
  buffer_load_dword v29, v5, s[60:63], s15 offen offset:256 sc1
  buffer_load_dwordx4 v[16:19], v4, s[60:63], s18 offen offset:1024 sc1
  buffer_load_dword v30, v5, s[60:63], s15 offen offset:512 sc1
  buffer_load_dwordx4 v[20:23], v4, s[60:63], s18 offen offset:2048 sc1
  buffer_load_dword v31, v5, s[60:63], s15 offen offset:768 sc1
  buffer_load_dwordx4 v[24:27], v4, s[60:63], s18 offen offset:3072 sc1
  s_waitcnt vmcnt(6)
  v_add3_u32 v6, v12, v13, v14
  v_add3_u32 v6, v6, v15, s7
  v_xor_b32 v7, v6, v28
  s_waitcnt vmcnt(4)
  v_add3_u32 v6, v16, v17, v18
  v_add3_u32 v6, v6, v19, s7
  v_xor_b32 v6, v6, v29
  v_or_b32 v7, v7, v6
  s_waitcnt vmcnt(2)
  v_add3_u32 v6, v20, v21, v22
  v_add3_u32 v6, v6, v23, s7
  v_xor_b32 v6, v6, v30
  v_or_b32 v7, v7, v6
  s_waitcnt vmcnt(0)
  v_add3_u32 v6, v24, v25, v26
  v_add3_u32 v6, v6, v27, s7
  v_xor_b32 v6, v6, v31
  v_or_b32 v7, v7, v6
  v_cmp_ne_u32 vcc, 0, v7
  s_nop 4
  s_cbranch_vccz PDONE_10
  s_sub_u32 s12, s12, 1
  s_cbranch_scc0 POLL_9
  s_mov_b32 s12, 0
PDONE_10:
  v_pk_add_f32 v[12:13], v[12:13], v[16:17]
  v_pk_add_f32 v[16:17], v[20:21], v[24:25]
  v_pk_add_f32 v[14:15], v[14:15], v[18:19]
  v_pk_add_f32 v[18:19], v[22:23], v[26:27]
  s_nop 1
  s_branch P_QA
P_S0C:
  s_barrier
  s_branch P_XR
P_LOOP:
  s_sub_u32 s3, s4, 5
  s_cmp_ge_u32 s4, 11
  s_subb_u32 s3, s3, 0
  s_cmp_eq_u32 s4, 11
  s_cselect_b32 s3, 99, s3
  s_waitcnt vmcnt(0)
  s_barrier
  s_cmp_eq_u32 s5, 0
  s_cbranch_scc1 P_R2
  v_add_u32 v7, 40960, v0
  ds_read_b64_tr_b16 v[44:45], v7 offset:0
  ds_read_b64_tr_b16 v[46:47], v7 offset:1024
  ds_read_b64_tr_b16 v[48:49], v7 offset:8192
  ds_read_b64_tr_b16 v[50:51], v7 offset:9216
  ds_read_b64_tr_b16 v[52:53], v7 offset:16384
  ds_read_b64_tr_b16 v[54:55], v7 offset:17408
  ds_read_b64_tr_b16 v[56:57], v7 offset:24576
  ds_read_b64_tr_b16 v[58:59], v7 offset:25600
  ds_read_b64_tr_b16 v[60:61], v7 offset:32768
  ds_read_b64_tr_b16 v[62:63], v7 offset:33792
  s_branch P_R3
P_R2:
  v_add_u32 v7, 122880, v0
  ds_read_b64_tr_b16 v[44:45], v7 offset:0
  ds_read_b64_tr_b16 v[46:47], v7 offset:1024
  ds_read_b64_tr_b16 v[48:49], v7 offset:8192
  ds_read_b64_tr_b16 v[50:51], v7 offset:9216
  ds_read_b64_tr_b16 v[52:53], v7 offset:16384
  ds_read_b64_tr_b16 v[54:55], v7 offset:17408
  ds_read_b64_tr_b16 v[56:57], v7 offset:24576
  ds_read_b64_tr_b16 v[58:59], v7 offset:25600
  v_lshl_or_b32 v60, v33, 16, v32
  v_lshl_or_b32 v61, v35, 16, v34
  v_lshl_or_b32 v62, v37, 16, v36
  v_lshl_or_b32 v63, v39, 16, v38
  s_nop 1
P_R3:
  s_cmp_eq_u32 s6, 0
  s_cbranch_scc1 P_CONS
  ds_read_b64_tr_b16 v[64:65], v0 offset:0
  ds_read_b64_tr_b16 v[66:67], v0 offset:1024
  ds_read_b64_tr_b16 v[68:69], v0 offset:8192
  ds_read_b64_tr_b16 v[70:71], v0 offset:9216
  ds_read_b64_tr_b16 v[72:73], v0 offset:16384
  ds_read_b64_tr_b16 v[74:75], v0 offset:17408
  ds_read_b64_tr_b16 v[76:77], v0 offset:24576
  ds_read_b64_tr_b16 v[78:79], v0 offset:25600
  ds_read_b64_tr_b16 v[80:81], v0 offset:32768
  ds_read_b64_tr_b16 v[82:83], v0 offset:33792
P_CONS:
  v_lshrrev_b32 v40, 3, v1
  v_and_b32 v41, 7, v1
  v_mul_u32_u24 v42, 1280, v40
  s_lshl_b32 s14, s3, 7
  s_add_u32 s15, s14, 393216
  v_lshl_add_u32 v42, v41, 4, v42
  v_add_u32 v42, s15, v42
  v_cmp_gt_u32 vcc, 7, v40
  v_mov_b32 v43, 0x7ff00000
  s_add_u32 s16, s11, 10240
  v_cndmask_b32 v43, v43, v42, vcc
  v_lshlrev_b32 v41, 4, v41
  v_lshl_add_u32 v41, v2, 2, v41
  v_add_u32 v41, s14, v41
  s_movk_i32 s24, 0x3f80
  s_mov_b32 s25, 0x3f800000
  s_add_u32 s17, s11, 20480
  s_add_u32 s18, s11, 30720
  s_add_u32 s19, s11, 40960
  s_add_u32 s20, s11, 51200
  s_add_u32 s21, s11, 61440
  s_cmp_lg_u32 s4, 5
  s_cbranch_scc1 P_SC
  v_min_u32 v16, 53, v1
  v_lshlrev_b32 v16, 7, v16
  v_add_u32 v16, 32768, v16
  s_nop 1
POLL_11:
  buffer_load_dwordx4 v[8:11], v16, s[60:63], s11 offen offset:0 sc1
  s_waitcnt vmcnt(0)
  v_xor_b32 v14, s7, v9
  v_xor_b32 v13, s7, v11
  v_or_b32 v14, v14, v13
  v_cmp_ne_u32 vcc, 0, v14
  s_nop 4
  s_cbranch_vccz PDONE_12
  s_sub_u32 s12, s12, 1
  s_cbranch_scc0 POLL_11
  s_mov_b32 s12, 0
PDONE_12:
P_SC:
  s_barrier
  s_cmp_ge_u32 s3, 10
  s_cbranch_scc1 P_B1
CONS_13:
  buffer_load_dwordx4 v[4:7], v42, s[60:63], s11 offen sc1
  buffer_load_dwordx4 v[8:11], v42, s[60:63], s16 offen sc1
  buffer_load_dwordx4 v[12:15], v42, s[60:63], s17 offen sc1
  buffer_load_dwordx4 v[16:19], v42, s[60:63], s18 offen sc1
  buffer_load_dwordx4 v[20:23], v42, s[60:63], s19 offen sc1
  buffer_load_dwordx4 v[24:27], v42, s[60:63], s20 offen sc1
  buffer_load_dwordx4 v[28:31], v43, s[60:63], s21 offen sc1
  s_waitcnt vmcnt(6)
  v_max3_u32 v40, v4, v5, v6
  v_max_u32 v40, v40, v7
  v_dot2_f32_bf16 v32, s24, v4, 0
  v_dot2_f32_bf16 v33, s25, v4, 0
  v_dot2_f32_bf16 v34, s24, v5, 0
  v_dot2_f32_bf16 v35, s25, v5, 0
  v_dot2_f32_bf16 v36, s24, v6, 0
  v_dot2_f32_bf16 v37, s25, v6, 0
  v_dot2_f32_bf16 v38, s24, v7, 0
  v_dot2_f32_bf16 v39, s25, v7, 0
  s_waitcnt vmcnt(5)
  v_max3_u32 v40, v40, v8, v9
  v_max3_u32 v40, v40, v10, v11
  v_dot2c_f32_bf16 v32, s24, v8
  v_dot2c_f32_bf16 v33, s25, v8
  v_dot2c_f32_bf16 v34, s24, v9
  v_dot2c_f32_bf16 v35, s25, v9
  v_dot2c_f32_bf16 v36, s24, v10
  v_dot2c_f32_bf16 v37, s25, v10
  v_dot2c_f32_bf16 v38, s24, v11
  v_dot2c_f32_bf16 v39, s25, v11
  s_waitcnt vmcnt(4)
  v_max3_u32 v40, v40, v12, v13
  v_max3_u32 v40, v40, v14, v15
  v_dot2c_f32_bf16 v32, s24, v12
  v_dot2c_f32_bf16 v33, s25, v12
  v_dot2c_f32_bf16 v34, s24, v13
  v_dot2c_f32_bf16 v35, s25, v13
  v_dot2c_f32_bf16 v36, s24, v14
  v_dot2c_f32_bf16 v37, s25, v14
  v_dot2c_f32_bf16 v38, s24, v15
  v_dot2c_f32_bf16 v39, s25, v15
  s_waitcnt vmcnt(3)
  v_max3_u32 v40, v40, v16, v17
  v_max3_u32 v40, v40, v18, v19
  v_dot2c_f32_bf16 v32, s24, v16
  v_dot2c_f32_bf16 v33, s25, v16
  v_dot2c_f32_bf16 v34, s24, v17
  v_dot2c_f32_bf16 v35, s25, v17
  v_dot2c_f32_bf16 v36, s24, v18
  v_dot2c_f32_bf16 v37, s25, v18
  v_dot2c_f32_bf16 v38, s24, v19
  v_dot2c_f32_bf16 v39, s25, v19
  s_waitcnt vmcnt(2)
  v_max3_u32 v40, v40, v20, v21
  v_max3_u32 v40, v40, v22, v23
  v_dot2c_f32_bf16 v32, s24, v20
  v_dot2c_f32_bf16 v33, s25, v20
  v_dot2c_f32_bf16 v34, s24, v21
  v_dot2c_f32_bf16 v35, s25, v21
  v_dot2c_f32_bf16 v36, s24, v22
  v_dot2c_f32_bf16 v37, s25, v22
  v_dot2c_f32_bf16 v38, s24, v23
  v_dot2c_f32_bf16 v39, s25, v23
  s_waitcnt vmcnt(1)
  v_max3_u32 v40, v40, v24, v25
  v_max3_u32 v40, v40, v26, v27
  v_dot2c_f32_bf16 v32, s24, v24
  v_dot2c_f32_bf16 v33, s25, v24
  v_dot2c_f32_bf16 v34, s24, v25
  v_dot2c_f32_bf16 v35, s25, v25
  v_dot2c_f32_bf16 v36, s24, v26
  v_dot2c_f32_bf16 v37, s25, v26
  v_dot2c_f32_bf16 v38, s24, v27
  v_dot2c_f32_bf16 v39, s25, v27
  s_waitcnt vmcnt(0)
  v_max3_u32 v40, v40, v28, v29
  v_max3_u32 v40, v40, v30, v31
  v_dot2c_f32_bf16 v32, s24, v28
  v_dot2c_f32_bf16 v33, s25, v28
  v_dot2c_f32_bf16 v34, s24, v29
  v_dot2c_f32_bf16 v35, s25, v29
  v_dot2c_f32_bf16 v36, s24, v30
  v_dot2c_f32_bf16 v37, s25, v30
  v_dot2c_f32_bf16 v38, s24, v31
  v_dot2c_f32_bf16 v39, s25, v31
  v_cmp_eq_u32 vcc, -1, v40
  s_nop 4
  s_cbranch_vccz CDONE_14
  s_sub_u32 s12, s12, 1
  s_cbranch_scc0 CONS_13
  s_mov_b32 s12, 0
CDONE_14:
  v_permlane32_swap_b32 v32, v36
  v_permlane32_swap_b32 v33, v37
  v_permlane32_swap_b32 v34, v38
  v_permlane32_swap_b32 v35, v39
  v_add_f32 v32, v32, v36
  v_add_f32 v33, v33, v37
  v_add_f32 v34, v34, v38
  v_add_f32 v35, v35, v39
  s_nop 0
  v_permlane16_swap_b32 v32, v34
  v_permlane16_swap_b32 v33, v35
  v_add_f32 v32, v32, v34
  v_add_f32 v33, v33, v35
  s_nop 0
  v_add_f32_dpp v32, v32, v32 row_ror:8 row_mask:0xf bank_mask:0xf
  v_add_f32_dpp v33, v33, v33 row_ror:8 row_mask:0xf bank_mask:0xf
  v_cvt_pk_bf16_f32 v32, v32, v33
  ds_write_b32 v41, v32 offset:0
  s_cmp_lg_u32 s59, 0
  s_cbranch_scc1 P_FIN
P_B1:
  s_add_u32 s11, s11, 4194304
  s_add_u32 s13, s13, 4194304
  s_mov_b32 s31, 64
  s_cmp_lg_u32 s6, 0
  s_cbranch_scc1 P_B1R
  ds_read_b64_tr_b16 v[24:25], v0 offset:0
  ds_read_b64_tr_b16 v[26:27], v0 offset:1024
  ds_read_b64_tr_b16 v[28:29], v0 offset:8192
  ds_read_b64_tr_b16 v[30:31], v0 offset:9216
  ds_read_b64_tr_b16 v[32:33], v0 offset:16384
  ds_read_b64_tr_b16 v[34:35], v0 offset:17408
  ds_read_b64_tr_b16 v[36:37], v0 offset:24576
  ds_read_b64_tr_b16 v[38:39], v0 offset:25600
  ds_read_b64_tr_b16 v[40:41], v0 offset:32768
  ds_read_b64_tr_b16 v[42:43], v0 offset:33792
  s_xor_b32 s15, s5, s9
  s_mul_i32 s14, s15, 320
  s_add_u32 s14, s14, 0
  v_mov_b32 v4, 1280
  v_mov_b32 v5, s14
  v_cmp_eq_u32 vcc, 0, v3
  s_nop 1
  v_cndmask_b32 v4, v4, v5, vcc
  v_lshl_add_u32 v4, v2, 4, v4
  s_and_b32 s15, s9, 1
  s_mul_i32 s15, s15, -640
  s_add_u32 s15, s15, 320
  v_mov_b32 v5, s15
  v_cndmask_b32 v5, 0, v5, vcc
  v_add_u32 v5, v5, v4
  s_lshl_b32 s14, s5, 9
  s_and_b32 s15, s4, 7
  s_lshl_b32 s15, s15, 6
  s_add_u32 s14, s14, s15
  v_lshlrev_b32 v6, 9, v3
  v_lshl_add_u32 v6, v2, 4, v6
  v_add_u32 v6, s14, v6
  s_waitcnt lgkmcnt(10)
  s_barrier
  s_branch P_S1
P_B1R:
  s_waitcnt lgkmcnt(0)
  s_barrier
P_S1:
  s_cmp_lg_u32 s6, 0
  s_cbranch_scc1 P_S1R
  ds_read_b128 v[8:11], v4 offset:0
  ds_read_b128 v[12:15], v4 offset:64
  ds_read_b128 v[16:19], v4 offset:128
  s_waitcnt lgkmcnt(2)
  v_mfma_f32_16x16x32_bf16 v[20:23], v[24:27], v[8:11], 0
  ds_read_b128 v[8:11], v4 offset:192
  ds_read_b128 v[24:27], v4 offset:256
  s_waitcnt lgkmcnt(3)
  v_mfma_f32_16x16x32_bf16 v[20:23], v[28:31], v[12:15], v[20:23]
  ds_read_b128 v[12:15], v5 offset:0
  ds_read_b128 v[28:31], v5 offset:64
  s_waitcnt lgkmcnt(4)
  v_mfma_f32_16x16x32_bf16 v[20:23], v[32:35], v[16:19], v[20:23]
  ds_read_b128 v[16:19], v5 offset:128
  ds_read_b128 v[32:35], v5 offset:192
  s_waitcnt lgkmcnt(5)
  v_mfma_f32_16x16x32_bf16 v[20:23], v[36:39], v[8:11], v[20:23]
  ds_read_b128 v[36:39], v5 offset:256
  s_waitcnt lgkmcnt(5)
  v_mfma_f32_16x16x32_bf16 v[20:23], v[40:43], v[24:27], v[20:23]
  s_waitcnt lgkmcnt(4)
  v_mfma_f32_16x16x32_bf16 v[20:23], v[44:47], v[12:15], v[20:23]
  s_waitcnt lgkmcnt(3)
  v_mfma_f32_16x16x32_bf16 v[20:23], v[48:51], v[28:31], v[20:23]
  s_waitcnt lgkmcnt(2)
  v_mfma_f32_16x16x32_bf16 v[20:23], v[52:55], v[16:19], v[20:23]
  s_waitcnt lgkmcnt(1)
  v_mfma_f32_16x16x32_bf16 v[20:23], v[56:59], v[32:35], v[20:23]
  s_waitcnt lgkmcnt(0)
  v_mfma_f32_16x16x32_bf16 v[20:23], v[60:63], v[36:39], v[20:23]
  s_mov_b64 exec, s[76:77]
  s_nop 6
  ds_write_b128 v6, v[20:23] offset:2048
  s_mov_b64 exec, -1
  s_branch P_S1E
P_S1R:
  ds_read_b128 v[8:11], v92 offset:0
  ds_read_b128 v[12:15], v92 offset:64
  ds_read_b128 v[16:19], v92 offset:128
  ds_read_b128 v[20:23], v92 offset:192
  ds_read_b128 v[24:27], v92 offset:256
  ds_read_b128 v[28:31], v93 offset:0
  ds_read_b128 v[32:35], v93 offset:64
  ds_read_b128 v[36:39], v93 offset:128
  ds_read_b128 v[40:43], v93 offset:192
  s_cmp_eq_u32 s4, 5
  s_cbranch_scc1 P_S1S
  s_cmp_eq_u32 s4, 12
  s_cbranch_scc1 P_S1S
  s_waitcnt lgkmcnt(8)
  v_mfma_f32_16x16x32_bf16 v[84:87], v[64:67], v[8:11], 0
  ds_read_b128 v[8:11], v93 offset:256
  s_waitcnt lgkmcnt(8)
  v_mfma_f32_16x16x32_bf16 v[84:87], v[68:71], v[12:15], v[84:87]
  s_waitcnt lgkmcnt(7)
  v_mfma_f32_16x16x32_bf16 v[84:87], v[72:75], v[16:19], v[84:87]
  s_waitcnt lgkmcnt(6)
  v_mfma_f32_16x16x32_bf16 v[84:87], v[76:79], v[20:23], v[84:87]
  s_waitcnt lgkmcnt(5)
  v_mfma_f32_16x16x32_bf16 v[84:87], v[80:83], v[24:27], v[84:87]
  s_waitcnt lgkmcnt(4)
  v_mfma_f32_16x16x32_bf16 v[84:87], v[44:47], v[28:31], v[84:87]
  s_waitcnt lgkmcnt(3)
  v_mfma_f32_16x16x32_bf16 v[84:87], v[48:51], v[32:35], v[84:87]
  s_waitcnt lgkmcnt(2)
  v_mfma_f32_16x16x32_bf16 v[84:87], v[52:55], v[36:39], v[84:87]
  s_waitcnt lgkmcnt(1)
  v_mfma_f32_16x16x32_bf16 v[84:87], v[56:59], v[40:43], v[84:87]
  s_waitcnt lgkmcnt(0)
  v_mfma_f32_16x16x32_bf16 v[84:87], v[60:63], v[8:11], v[84:87]
  s_mov_b64 exec, s[76:77]
  s_nop 6
  ds_write_b128 v94, v[84:87] offset:2048
  s_mov_b64 exec, -1
  s_branch P_S1E
P_S1S:
  s_waitcnt lgkmcnt(8)
  v_mfma_f32_16x16x32_bf16 v[84:87], v[64:67], v[8:11], 0
  v_mfma_f32_16x16x32_bf16 v[88:91], v[8:11], v[8:11], 0
  ds_read_b128 v[8:11], v93 offset:256
  s_waitcnt lgkmcnt(8)
  v_mfma_f32_16x16x32_bf16 v[84:87], v[68:71], v[12:15], v[84:87]
  v_mfma_f32_16x16x32_bf16 v[88:91], v[12:15], v[12:15], v[88:91]
  s_waitcnt lgkmcnt(7)
  v_mfma_f32_16x16x32_bf16 v[84:87], v[72:75], v[16:19], v[84:87]
  v_mfma_f32_16x16x32_bf16 v[88:91], v[16:19], v[16:19], v[88:91]
  s_waitcnt lgkmcnt(6)
  v_mfma_f32_16x16x32_bf16 v[84:87], v[76:79], v[20:23], v[84:87]
  v_mfma_f32_16x16x32_bf16 v[88:91], v[20:23], v[20:23], v[88:91]
  s_waitcnt lgkmcnt(5)
  v_mfma_f32_16x16x32_bf16 v[84:87], v[80:83], v[24:27], v[84:87]
  v_mfma_f32_16x16x32_bf16 v[88:91], v[24:27], v[24:27], v[88:91]
  s_waitcnt lgkmcnt(4)
  v_mfma_f32_16x16x32_bf16 v[84:87], v[44:47], v[28:31], v[84:87]
  v_mfma_f32_16x16x32_bf16 v[88:91], v[28:31], v[28:31], v[88:91]
  s_waitcnt lgkmcnt(3)
  v_mfma_f32_16x16x32_bf16 v[84:87], v[48:51], v[32:35], v[84:87]
  v_mfma_f32_16x16x32_bf16 v[88:91], v[32:35], v[32:35], v[88:91]
  s_waitcnt lgkmcnt(2)
  v_mfma_f32_16x16x32_bf16 v[84:87], v[52:55], v[36:39], v[84:87]
  v_mfma_f32_16x16x32_bf16 v[88:91], v[36:39], v[36:39], v[88:91]
  s_waitcnt lgkmcnt(1)
  v_mfma_f32_16x16x32_bf16 v[84:87], v[56:59], v[40:43], v[84:87]
  v_mfma_f32_16x16x32_bf16 v[88:91], v[40:43], v[40:43], v[88:91]
  s_waitcnt lgkmcnt(0)
  v_mfma_f32_16x16x32_bf16 v[84:87], v[60:63], v[8:11], v[84:87]
  v_mfma_f32_16x16x32_bf16 v[88:91], v[8:11], v[8:11], v[88:91]
  s_lshl_b32 s14, s5, 2
  v_mov_b32 v4, s14
  s_mov_b64 exec, 1
  s_nop 4
  ds_write_b64 v4, v[88:89] offset:1856
  s_mov_b64 exec, s[76:77]
  ds_write_b128 v94, v[84:87] offset:2048
  s_mov_b64 exec, -1
P_S1E:
  s_waitcnt lgkmcnt(0)
  s_barrier
  s_cmp_lg_u32 s4, 0
  s_cbranch_scc1 P_NSF1
  s_lshl_b32 s14, s8, 2
  s_add_u32 s14, s14, s9
  s_lshl_b32 s14, s14, 7
  v_mov_b32 v7, s14
  v_mov_b32 v21, s7
  v_mov_b32 v23, s7
  s_mov_b64 exec, 1
  buffer_store_dwordx4 v[20:23], v7, s[60:63], s11 offen offset:0 sc1
  s_mov_b64 exec, -1
  s_nop 0
P_NSF1:
  s_sub_u32 s14, s4, 8
  s_cmp_ge_u32 s14, 4
  s_cbranch_scc1 P_XR
  v_lshlrev_b32 v4, 4, v1
  v_mov_b32 v5, 0
  ds_read_b128 v[20:23], v5 offset:1856
  ds_read_b128 v[12:15], v4 offset:2048
  ds_read_b128 v[16:19], v4 offset:3072
  s_waitcnt lgkmcnt(2)
  v_pk_add_f32 v[32:33], v[20:21], v[22:23]
  v_mul_f32 v33, 1.562500000000e-03, v33
  v_mul_f32 v32, 1.562500000000e-03, v32
  v_fma_f32 v34, -v33, v33, v32
  v_max_f32 v34, 0, v34
  v_add_f32 v34, 1.0e-5, v34
  v_rsq_f32 v32, v34
  s_waitcnt lgkmcnt(0)
  s_nop 0
  s_branch P_NSF
P_QA:
  s_cmp_lg_u32 s4, 8
  s_cbranch_scc1 P_NSF
  s_lshl_b32 s14, s8, 2
  s_add_u32 s14, s14, s9
  s_lshl_b32 s14, s14, 7
  v_mov_b32 v7, s14
  v_mov_b32 v21, s7
  v_mov_b32 v23, s7
  s_mov_b64 exec, 1
  buffer_store_dwordx4 v[20:23], v7, s[60:63], s11 offen offset:0 sc1
  s_mov_b64 exec, -1
  s_nop 0
P_NSF:
  v_pk_add_f32 v[12:13], v[12:13], v[16:17]
  v_pk_add_f32 v[14:15], v[14:15], v[18:19]
  v_mov_b32 v16, v12
  v_mov_b32 v17, v13
  v_mov_b32 v18, v14
  v_mov_b32 v19, v15
  v_permlane32_swap_b32 v12, v16
  v_permlane32_swap_b32 v13, v17
  v_permlane32_swap_b32 v14, v18
  v_permlane32_swap_b32 v15, v19
  v_fma_f32 v12, -v33, v16, v12
  v_fma_f32 v13, -v33, v17, v13
  v_fma_f32 v14, -v33, v18, v14
  v_fma_f32 v15, -v33, v19, v15
  v_mul_f32 v12, v12, v32
  v_mul_f32 v13, v13, v32
  v_mul_f32 v14, v14, v32
  v_mul_f32 v15, v15, v32
  v_cvt_pk_bf16_f32 v12, v12, v13
  v_cvt_pk_bf16_f32 v13, v14, v15
  s_lshl_b32 s14, s4, 8
  v_and_b32 v14, 31, v1
  v_lshl_add_u32 v14, v14, 3, s14
  v_lshl_add_u32 v15, v2, 4, s14
  ds_write_b64 v14, v[12:13] offset:4096
  ds_read_b128 v[16:19], v15 offset:4096
  ds_read_b128 v[20:23], v15 offset:4160
  ds_read_b128 v[24:27], v15 offset:4224
  ds_read_b128 v[28:31], v15 offset:4288
  s_lshl_b32 s14, s8, 10
  s_lshl_b32 s15, s9, 8
  s_add_u32 s14, s14, s15
  s_sub_u32 s15, s4, 8
  s_lshl_b32 s15, s15, 6
  s_add_u32 s14, s14, s15
  s_add_u32 s14, s14, 131072
  v_lshl_add_u32 v4, v2, 4, s14
  s_mov_b32 s15, 1040356334
  s_waitcnt lgkmcnt(3)
  v_mfma_f32_16x16x32_bf16 v[32:35], v[64:67], v[16:19], 0
  v_mfma_f32_16x16x32_bf16 v[36:39], v[80:83], v[16:19], 0
  s_waitcnt lgkmcnt(2)
  v_mfma_f32_16x16x32_bf16 v[32:35], v[68:71], v[20:23], v[32:35]
  v_mfma_f32_16x16x32_bf16 v[36:39], v[84:87], v[20:23], v[36:39]
  s_waitcnt lgkmcnt(1)
  v_mfma_f32_16x16x32_bf16 v[32:35], v[72:75], v[24:27], v[32:35]
  v_mfma_f32_16x16x32_bf16 v[36:39], v[88:91], v[24:27], v[36:39]
  s_waitcnt lgkmcnt(0)
  v_mfma_f32_16x16x32_bf16 v[32:35], v[76:79], v[28:31], v[32:35]
  v_mfma_f32_16x16x32_bf16 v[36:39], v[92:95], v[28:31], v[36:39]
  s_nop 6
  v_mul_f32 v32, s15, v32
  v_mul_f32 v33, s15, v33
  v_mul_f32 v34, s15, v34
  v_mul_f32 v35, s15, v35
  v_mul_f32 v36, s15, v36
  v_mul_f32 v37, s15, v37
  v_mul_f32 v38, s15, v38
  v_mul_f32 v39, s15, v39
  v_cvt_pk_bf16_f32 v8, v32, v33
  v_cvt_pk_bf16_f32 v9, v34, v35
  v_cvt_pk_bf16_f32 v10, v36, v37
  v_cvt_pk_bf16_f32 v11, v38, v39
  s_mov_b64 exec, s[78:79]
  buffer_store_dwordx4 v[8:11], v4, s[60:63], s11 offen offset:0 sc1
  s_mov_b64 exec, -1
  s_nop 0
  s_branch P_MID
P_XR:
  s_cmp_lg_u32 s8, 0
  s_cbranch_scc1 P_MID
  s_cmp_lg_u32 s4, 12
  s_cbranch_scc1 P_MID
  s_mul_i32 s16, s9, 320
  s_add_u32 s17, s16, 368640
  s_sub_u32 s14, s4, 12
  s_lshl_b32 s14, s14, 6
  v_add_u32 v4, s14, v1
  v_cmp_gt_u32 vcc, 20, v4
  s_nop 0
  s_and_saveexec_b64 s[26:27], vcc
  s_nop 2
  s_cbranch_execz P_XRW_x
  v_lshlrev_b32 v4, 4, v4
  v_add_u32 v5, s16, v4
  v_add_u32 v4, s17, v4
  ds_read_b128 v[8:11], v5 offset:0
  s_waitcnt lgkmcnt(0)
  buffer_store_dwordx4 v[8:11], v4, s[60:63], s11 offen offset:0 sc1
  s_nop 1
P_XRW_x:
  s_mov_b64 exec, -1
P_MID:
  s_barrier
  s_cmp_lg_u32 s58, 0
  s_cbranch_scc1 P_H2
  s_mov_b32 s64, s40
  s_mov_b32 s65, s41
  s_mov_b32 s66, 4194304
  s_mov_b32 s67, 0x00020000
  s_mov_b32 s68, s42
  s_mov_b32 s69, s43
  s_mov_b32 s70, 5242880
  s_mov_b32 s71, 0x00020000
  v_lshlrev_b32 v4, 13, v2
  s_and_b32 s14, s4, 1
  s_lshl_b32 s14, s14, 3
  v_lshl_or_b32 v5, v2, 1, s14
  v_xor_b32 v5, v5, v3
  v_lshl_add_u32 v4, v5, 4, v4
  s_lshl_b32 s14, s9, 20
  s_lshl_b32 s15, s8, 8
  s_add_u32 s14, s14, s15
  s_lshl_b32 s16, s4, 15
  s_add_u32 s14, s14, s16
  s_lshl_b32 s16, s4, 10
  s_add_u32 s17, s16, 131072
  s_mov_b32 m0, s17
  s_nop 0
  buffer_load_dwordx4 v4, s[64:67], s14 offen nt lds
  s_add_u32 s14, s14, 524288
  s_add_u32 s17, s17, 16384
  s_mov_b32 m0, s17
  s_nop 0
  buffer_load_dwordx4 v4, s[64:67], s14 offen nt lds
  s_mul_i32 s14, s8, 163840
  s_mul_i32 s15, s9, 320
  s_add_u32 s14, s14, s15
  s_add_u32 s17, s16, 90112
  s_mov_b32 s18, 3277
  s_lshl_b32 s19, s4, 6
  s_add_u32 s19, s19, 0
  v_add_u32 v5, s19, v1
  v_mul_lo_u32 v6, v5, s18
  v_lshrrev_b32 v6, 16, v6
  v_mul_u32_u24 v7, 20, v6
  v_sub_u32 v5, v5, v7
  v_mul_u32_u24 v6, 1280, v6
  v_lshl_add_u32 v8, v5, 4, v6
  s_mov_b32 m0, s17
  s_nop 0
  buffer_load_dwordx4 v8, s[68:71], s14 offen nt lds
  s_add_u32 s17, s17, 16384
  s_lshl_b32 s19, s4, 6
  s_add_u32 s19, s19, 1024
  v_add_u32 v5, s19, v1
  v_mul_lo_u32 v6, v5, s18
  v_lshrrev_b32 v6, 16, v6
  v_mul_u32_u24 v7, 20, v6
  v_sub_u32 v5, v5, v7
  v_mul_u32_u24 v6, 1280, v6
  v_lshl_add_u32 v9, v5, 4, v6
  s_mov_b32 m0, s17
  s_nop 0
  buffer_load_dwordx4 v9, s[68:71], s14 offen nt lds
  s_add_u32 s17, s17, 16384
  s_cmp_ge_u32 s4, 8
  s_cbranch_scc1 P_B2
  s_lshl_b32 s19, s4, 6
  s_add_u32 s19, s19, 2048
  v_add_u32 v5, s19, v1
  v_mul_lo_u32 v6, v5, s18
  v_lshrrev_b32 v6, 16, v6
  v_mul_u32_u24 v7, 20, v6
  v_sub_u32 v5, v5, v7
  v_mul_u32_u24 v6, 1280, v6
  v_lshl_add_u32 v10, v5, 4, v6
  s_mov_b32 m0, s17
  s_nop 0
  buffer_load_dwordx4 v10, s[68:71], s14 offen nt lds
  s_add_u32 s17, s17, 16384
P_B2:
  s_mov_b32 s64, s36
  s_mov_b32 s65, s37
  s_mov_b32 s66, 5242880
  s_mov_b32 s67, 0x00020000
  s_waitcnt vmcnt(0)
  s_barrier
  s_and_b32 s14, s4, 3
  s_lshl_b32 s14, s14, 13
  s_add_u32 s14, s14, 131072
  v_lshrrev_b32 v12, 2, v1
  v_and_b32 v13, 7, v12
  v_lshlrev_b32 v12, 8, v12
  v_lshl_add_u32 v12, v13, 5, v12
  v_and_b32 v14, 3, v1
  v_lshl_add_u32 v12, v14, 3, v12
  v_add_u32 v12, s14, v12
  v_xor_b32 v13, 0, v12
  ds_read_b64_tr_b16 v[96:97], v13 offset:0
  ds_read_b64_tr_b16 v[98:99], v13 offset:4096
  v_xor_b32 v13, 32, v12
  ds_read_b64_tr_b16 v[100:101], v13 offset:0
  ds_read_b64_tr_b16 v[102:103], v13 offset:4096
  v_xor_b32 v13, 64, v12
  ds_read_b64_tr_b16 v[104:105], v13 offset:0
  ds_read_b64_tr_b16 v[106:107], v13 offset:4096
  v_xor_b32 v13, 96, v12
  ds_read_b64_tr_b16 v[108:109], v13 offset:0
  ds_read_b64_tr_b16 v[110:111], v13 offset:4096
  v_xor_b32 v13, 128, v12
  ds_read_b64_tr_b16 v[112:113], v13 offset:0
  ds_read_b64_tr_b16 v[114:115], v13 offset:4096
  v_xor_b32 v13, 160, v12
  ds_read_b64_tr_b16 v[116:117], v13 offset:0
  ds_read_b64_tr_b16 v[118:119], v13 offset:4096
  v_xor_b32 v13, 192, v12
  ds_read_b64_tr_b16 v[120:121], v13 offset:0
  ds_read_b64_tr_b16 v[122:123], v13 offset:4096
  v_xor_b32 v13, 224, v12
  ds_read_b64_tr_b16 v[124:125], v13 offset:0
  ds_read_b64_tr_b16 v[126:127], v13 offset:4096
  s_cmp_ge_u32 s4, 5
  s_cbranch_scc1 P_H2
  v_lshrrev_b32 v12, 2, v3
  v_lshl_add_u32 v12, v2, 3, v12
  v_mul_u32_u24 v12, 320, v12
  v_lshl_add_u32 v12, v14, 4, v12
  s_lshl_b32 s14, s4, 6
  s_add_u32 s14, s14, 90112
  v_add_u32 v12, s14, v12
  ds_read_b64_tr_b16 v[64:65], v12 offset:0
  ds_read_b64_tr_b16 v[66:67], v12 offset:1280
  ds_read_b64_tr_b16 v[68:69], v12 offset:10240
  ds_read_b64_tr_b16 v[70:71], v12 offset:11520
  ds_read_b64_tr_b16 v[72:73], v12 offset:20480
  ds_read_b64_tr_b16 v[74:75], v12 offset:21760
  ds_read_b64_tr_b16 v[76:77], v12 offset:30720
  ds_read_b64_tr_b16 v[78:79], v12 offset:32000
  ds_read_b64_tr_b16 v[80:81], v12 offset:8
  ds_read_b64_tr_b16 v[82:83], v12 offset:1288
  ds_read_b64_tr_b16 v[84:85], v12 offset:10248
  ds_read_b64_tr_b16 v[86:87], v12 offset:11528
  ds_read_b64_tr_b16 v[88:89], v12 offset:20488
  ds_read_b64_tr_b16 v[90:91], v12 offset:21768
  ds_read_b64_tr_b16 v[92:93], v12 offset:30728
  ds_read_b64_tr_b16 v[94:95], v12 offset:32008
P_H2:
  s_lshl_b32 s14, s8, 2
  s_add_u32 s14, s14, s9
  s_lshl_b32 s14, s14, 14
  s_lshr_b32 s15, s4, 2
  s_lshl_b32 s16, s15, 12
  s_add_u32 s14, s14, s16
  s_and_b32 s16, s4, 3
  s_lshl_b32 s16, s16, 6
  s_add_u32 s14, s14, s16
  s_add_u32 s14, s14, 1048576
  v_lshlrev_b32 v40, 8, v3
  v_lshl_add_u32 v40, v2, 4, v40
  v_add_u32 v40, s14, v40
  s_lshl_b32 s14, s15, 6
  v_lshl_add_u32 v44, v2, 4, s14
  s_lshl_b32 s14, s4, 9
  s_add_u32 s14, s14, 131072
  v_lshlrev_b32 v48, 7, v2
  v_lshl_add_u32 v48, v3, 2, v48
  v_add_u32 v48, s14, v48
  s_cmp_lg_u32 s4, 15
  s_nop 0
  s_cbranch_scc1 P_H2B
  s_lshl_b32 s14, s8, 13
  s_add_u32 s14, s14, 786432
  v_lshl_add_u32 v41, v1, 7, s14
  s_nop 1
POLL_15:
  buffer_load_dwordx4 v[8:11], v41, s[60:63], s11 offen offset:0 sc1
  s_waitcnt vmcnt(0)
  v_xor_b32 v13, s7, v9
  v_xor_b32 v12, s7, v11
  v_or_b32 v13, v13, v12
  v_cmp_ne_u32 vcc, 0, v13
  s_nop 4
  s_cbranch_vccz PDONE_16
  s_sub_u32 s12, s12, 1
  s_cbranch_scc0 POLL_15
  s_mov_b32 s12, 0
PDONE_16:
  s_barrier
  buffer_load_dwordx4 v[4:7], v40, s[60:63], s11 offen sc1
  v_mov_b32 v12, v8
  s_nop 1
  v_max_f32_dpp v12, v12, v12 row_ror:8 row_mask:0xf bank_mask:0xf
  s_nop 1
  v_max_f32_dpp v12, v12, v12 row_ror:4 row_mask:0xf bank_mask:0xf
  s_nop 1
  v_max_f32_dpp v12, v12, v12 row_ror:2 row_mask:0xf bank_mask:0xf
  s_nop 1
  v_max_f32_dpp v12, v12, v12 row_ror:1 row_mask:0xf bank_mask:0xf
  v_mov_b32 v13, v12
  s_nop 1
  v_permlane32_swap_b32 v12, v13
  v_max_f32 v12, v12, v13
  v_mov_b32 v13, v12
  s_nop 1
  v_permlane16_swap_b32 v12, v13
  v_max_f32 v12, v12, v13
  v_sub_f32 v8, v8, v12
  v_exp_f32 v8, v8
  s_nop 0
  v_mul_f32 v10, v10, v8
  s_nop 1
  v_add_f32_dpp v10, v10, v10 row_ror:8 row_mask:0xf bank_mask:0xf
  s_nop 1
  v_add_f32_dpp v10, v10, v10 row_ror:4 row_mask:0xf bank_mask:0xf
  s_nop 1
  v_add_f32_dpp v10, v10, v10 row_ror:2 row_mask:0xf bank_mask:0xf
  s_nop 1
  v_add_f32_dpp v10, v10, v10 row_ror:1 row_mask:0xf bank_mask:0xf
  v_mov_b32 v13, v10
  s_nop 1
  v_permlane32_swap_b32 v10, v13
  v_add_f32 v10, v10, v13
  v_mov_b32 v13, v10
  s_nop 1
  v_permlane16_swap_b32 v10, v13
  v_add_f32 v10, v10, v13
  v_rcp_f32 v10, v10
  v_lshlrev_b32 v12, 2, v1
  v_mul_f32 v8, v8, v10
  ds_write_b32 v12, v8 offset:1600
  s_waitcnt lgkmcnt(0)
  s_branch P_H2D
P_H2B:
  s_waitcnt lgkmcnt(0)
  s_barrier
  buffer_load_dwordx4 v[4:7], v40, s[60:63], s11 offen sc1
P_H2D:
  s_barrier
  ds_read_b128 v[44:47], v44 offset:1600
  s_waitcnt vmcnt(0)
  v_max3_u32 v12, v4, v5, v6
  v_max_u32 v12, v12, v7
  v_cmp_eq_u32 vcc, -1, v12
  s_nop 4
  s_cbranch_vccz P_H2C
POLL_17:
  buffer_load_dwordx4 v[4:7], v40, s[60:63], s11 offen offset:0 sc1
  s_waitcnt vmcnt(0)
  v_max3_u32 v14, v4, v5, v6
  v_max_u32 v14, v14, v7
  v_cmp_eq_u32 vcc, -1, v14
  s_nop 4
  s_cbranch_vccz PDONE_18
  s_sub_u32 s12, s12, 1
  s_cbranch_scc0 POLL_17
  s_mov_b32 s12, 0
PDONE_18:
P_H2C:
  v_mfma_f32_16x16x32_bf16 v[8:11], v[4:7], v[96:99], 0
  v_mfma_f32_16x16x32_bf16 v[12:15], v[4:7], v[100:103], 0
  v_mfma_f32_16x16x32_bf16 v[16:19], v[4:7], v[104:107], 0
  v_mfma_f32_16x16x32_bf16 v[20:23], v[4:7], v[108:111], 0
  v_mfma_f32_16x16x32_bf16 v[24:27], v[4:7], v[112:115], 0
  v_mfma_f32_16x16x32_bf16 v[28:31], v[4:7], v[116:119], 0
  v_mfma_f32_16x16x32_bf16 v[32:35], v[4:7], v[120:123], 0
  v_mfma_f32_16x16x32_bf16 v[36:39], v[4:7], v[124:127], 0
  s_waitcnt lgkmcnt(0)
  v_pk_mul_f32 v[8:9], v[8:9], v[44:45]
  v_pk_fma_f32 v[8:9], v[10:11], v[46:47], v[8:9]
  v_pk_mul_f32 v[12:13], v[12:13], v[44:45]
  v_pk_fma_f32 v[12:13], v[14:15], v[46:47], v[12:13]
  v_pk_mul_f32 v[16:17], v[16:17], v[44:45]
  v_pk_fma_f32 v[16:17], v[18:19], v[46:47], v[16:17]
  v_pk_mul_f32 v[20:21], v[20:21], v[44:45]
  v_pk_fma_f32 v[20:21], v[22:23], v[46:47], v[20:21]
  v_pk_mul_f32 v[24:25], v[24:25], v[44:45]
  v_pk_fma_f32 v[24:25], v[26:27], v[46:47], v[24:25]
  v_pk_mul_f32 v[28:29], v[28:29], v[44:45]
  v_pk_fma_f32 v[28:29], v[30:31], v[46:47], v[28:29]
  v_pk_mul_f32 v[32:33], v[32:33], v[44:45]
  v_pk_fma_f32 v[32:33], v[34:35], v[46:47], v[32:33]
  v_pk_mul_f32 v[36:37], v[36:37], v[44:45]
  v_pk_fma_f32 v[36:37], v[38:39], v[46:47], v[36:37]
  v_add_f32 v8, v8, v9
  v_add_f32 v12, v12, v13
  v_add_f32 v16, v16, v17
  v_add_f32 v20, v20, v21
  v_add_f32 v24, v24, v25
  v_add_f32 v28, v28, v29
  v_add_f32 v32, v32, v33
  v_add_f32 v36, v36, v37
  v_permlane32_swap_b32 v8, v24
  v_permlane32_swap_b32 v12, v28
  v_permlane32_swap_b32 v16, v32
  v_permlane32_swap_b32 v20, v36
  v_add_f32 v8, v8, v24
  v_add_f32 v12, v12, v28
  v_add_f32 v16, v16, v32
  v_add_f32 v20, v20, v36
  s_nop 0
  v_permlane16_swap_b32 v8, v16
  v_permlane16_swap_b32 v12, v20
  v_add_f32 v8, v8, v16
  v_add_f32 v12, v12, v20
  ds_write2_b32 v48, v8, v12 offset0:0 offset1:16
  s_waitcnt lgkmcnt(0)
  s_barrier
  s_cmp_lg_u32 s4, 5
  s_cbranch_scc1 P_B4
  v_lshrrev_b32 v5, 5, v1
  v_and_b32 v4, 31, v1
  v_lshlrev_b32 v4, 4, v4
  v_lshl_add_u32 v5, v5, 12, v4
  v_add_u32 v5, 131072, v5
  ds_read_b128 v[8:11], v5 offset:0
  ds_read_b128 v[12:15], v5 offset:512
  ds_read_b128 v[16:19], v5 offset:1024
  ds_read_b128 v[20:23], v5 offset:1536
  ds_read_b128 v[24:27], v5 offset:2048
  ds_read_b128 v[28:31], v5 offset:2560
  ds_read_b128 v[32:35], v5 offset:3072
  ds_read_b128 v[36:39], v5 offset:3584
  s_lshl_b32 s14, s8, 2
  s_add_u32 s14, s14, s9
  s_lshl_b32 s14, s14, 9
  s_add_u32 s14, s14, 262144
  v_add_u32 v4, s14, v4
  v_subrev_u32 v6, 0x10000, v4
  s_waitcnt lgkmcnt(6)
  v_pk_add_f32 v[8:9], v[8:9], v[12:13]
  v_pk_add_f32 v[10:11], v[10:11], v[14:15]
  s_waitcnt lgkmcnt(4)
  v_pk_add_f32 v[16:17], v[16:17], v[20:21]
  v_pk_add_f32 v[18:19], v[18:19], v[22:23]
  s_waitcnt lgkmcnt(2)
  v_pk_add_f32 v[24:25], v[24:25], v[28:29]
  v_pk_add_f32 v[26:27], v[26:27], v[30:31]
  s_waitcnt lgkmcnt(0)
  v_pk_add_f32 v[32:33], v[32:33], v[36:37]
  v_pk_add_f32 v[34:35], v[34:35], v[38:39]
  v_pk_add_f32 v[8:9], v[8:9], v[16:17]
  v_pk_add_f32 v[10:11], v[10:11], v[18:19]
  v_pk_add_f32 v[24:25], v[24:25], v[32:33]
  v_pk_add_f32 v[26:27], v[26:27], v[34:35]
  v_pk_add_f32 v[8:9], v[8:9], v[24:25]
  v_pk_add_f32 v[10:11], v[10:11], v[26:27]
  v_mov_b32 v12, v8
  v_mov_b32 v13, v9
  v_mov_b32 v14, v10
  v_mov_b32 v15, v11
  v_permlane32_swap_b32 v8, v12
  v_permlane32_swap_b32 v9, v13
  v_permlane32_swap_b32 v10, v14
  v_permlane32_swap_b32 v11, v15
  v_pk_add_f32 v[8:9], v[8:9], v[12:13]
  v_pk_add_f32 v[10:11], v[10:11], v[14:15]
  s_mov_b32 exec_hi, 0
  buffer_store_dwordx4 v[8:11], v6, s[60:63], s11 offen
  buffer_store_dwordx4 v[8:11], v4, s[60:63], s11 offen offset:0 sc1
  s_mov_b64 exec, -1
  s_nop 0
P_B4:
  s_barrier
  s_cmp_lg_u32 s4, 5
  s_cbranch_scc1 P_NOF
  s_lshl_b32 s14, s10, 7
  s_add_u32 s14, s14, 16384
  v_mov_b32 v5, s14
  v_mov_b32 v17, s7
  v_mov_b32 v19, s7
  s_mov_b64 exec, 1
  buffer_store_dwordx4 v[16:19], v5, s[60:63], s11 offen offset:0 sc1
  s_mov_b64 exec, -1
  s_nop 0
P_NOF:
  s_cmp_ge_u32 s4, 5
  s_cbranch_scc1 P_NEXT
  s_lshl_b32 s14, s8, 11
  s_add_u32 s14, s14, 196608
  v_lshl_add_u32 v4, v1, 4, s14
  s_add_u32 s16, s11, 0x10000
  s_mov_b32 s17, 0
  s_lshl_b32 s14, s10, 7
  s_add_u32 s14, s14, 16384
  v_mov_b32 v5, s14
  s_nop 1
POLL_19:
  s_add_u32 s17, s17, 1
  s_and_b32 s18, s17, 7
  s_cselect_b32 s18, s11, s16
  buffer_load_dwordx4 v[12:15], v4, s[60:63], s18 offen offset:0 sc1
  buffer_load_dwordx4 v[16:19], v4, s[60:63], s18 offen offset:1024 sc1
  s_waitcnt vmcnt(1)
  v_max3_u32 v8, v12, v13, v14
  v_max_u32 v8, v8, v15
  s_waitcnt vmcnt(0)
  v_max3_u32 v8, v8, v16, v17
  v_max3_u32 v8, v8, v18, v19
  v_cmp_eq_u32 vcc, -1, v8
  s_nop 4
  s_cbranch_vccz PDONE_20
  s_sub_u32 s12, s12, 1
  s_cbranch_scc0 POLL_19
  s_mov_b32 s12, 0
PDONE_20:
  v_pk_add_f32 v[12:13], v[12:13], v[16:17]
  v_pk_add_f32 v[14:15], v[14:15], v[18:19]
  v_mov_b32 v16, v12
  v_mov_b32 v17, v13
  v_mov_b32 v18, v14
  v_mov_b32 v19, v15
  v_permlane32_swap_b32 v12, v16
  v_permlane32_swap_b32 v13, v17
  v_permlane32_swap_b32 v14, v18
  v_permlane32_swap_b32 v15, v19
  v_pk_add_f32 v[12:13], v[12:13], v[16:17]
  v_pk_add_f32 v[14:15], v[14:15], v[18:19]
  v_cvt_pk_bf16_f32 v12, v12, v13
  v_cvt_pk_bf16_f32 v13, v14, v15
  s_lshl_b32 s14, s4, 8
  v_and_b32 v14, 31, v1
  v_lshl_add_u32 v14, v14, 3, s14
  v_lshl_add_u32 v15, v2, 4, s14
  ds_write_b64 v14, v[12:13] offset:4096
  ds_read_b128 v[16:19], v15 offset:4096
  ds_read_b128 v[20:23], v15 offset:4160
  ds_read_b128 v[24:27], v15 offset:4224
  ds_read_b128 v[28:31], v15 offset:4288
  s_mul_i32 s14, s8, 1280
  s_mul_i32 s15, s9, 320
  s_add_u32 s14, s14, s15
  s_lshl_b32 s15, s4, 6
  s_add_u32 s14, s14, s15
  s_add_u32 s14, s14, 327680
  v_lshl_add_u32 v4, v2, 4, s14
  s_waitcnt lgkmcnt(3)
  v_mfma_f32_16x16x32_bf16 v[32:35], v[64:67], v[16:19], 0
  v_mfma_f32_16x16x32_bf16 v[36:39], v[80:83], v[16:19], 0
  s_waitcnt lgkmcnt(2)
  v_mfma_f32_16x16x32_bf16 v[32:35], v[68:71], v[20:23], v[32:35]
  v_mfma_f32_16x16x32_bf16 v[36:39], v[84:87], v[20:23], v[36:39]
  s_waitcnt lgkmcnt(1)
  v_mfma_f32_16x16x32_bf16 v[32:35], v[72:75], v[24:27], v[32:35]
  v_mfma_f32_16x16x32_bf16 v[36:39], v[88:91], v[24:27], v[36:39]
  s_waitcnt lgkmcnt(0)
  v_mfma_f32_16x16x32_bf16 v[32:35], v[76:79], v[28:31], v[32:35]
  v_mfma_f32_16x16x32_bf16 v[36:39], v[92:95], v[28:31], v[36:39]
  s_nop 6
  v_cvt_pk_bf16_f32 v8, v32, v33
  v_cvt_pk_bf16_f32 v9, v34, v35
  v_cvt_pk_bf16_f32 v10, v36, v37
  v_cvt_pk_bf16_f32 v11, v38, v39
  s_mov_b64 exec, s[78:79]
  buffer_store_dwordx4 v[8:11], v4, s[60:63], s11 offen offset:0 sc1
  s_mov_b64 exec, -1
  s_nop 0
P_NEXT:
  s_barrier
  s_cmp_lg_u32 s58, 0
  s_cbranch_scc1 P_LAST
  s_mov_b32 s58, 1
  v_lshlrev_b32 v4, 13, v2
  s_bfe_u32 s14, s4, 0x10001
  s_lshl_b32 s14, s14, 3
  v_lshl_or_b32 v5, v2, 1, s14
  v_xor_b32 v5, v5, v3
  v_lshl_add_u32 v4, v5, 4, v4
  s_xor_b32 s15, s9, 2
  s_mul_i32 s15, s15, 1310720
  s_lshl_b32 s14, s8, 8
  s_add_u32 s15, s15, s14
  s_lshl_b32 s14, s4, 15
  s_add_u32 s14, s14, s15
  s_lshl_b32 s16, s4, 10
  s_add_u32 s16, s16, 49152
  s_mov_b32 m0, s16
  s_nop 0
  buffer_load_dwordx4 v4, s[64:67], s14 offen nt lds
  s_add_u32 s14, s14, 524288
  s_add_u32 s16, s16, 16384
  s_mov_b32 m0, s16
  s_nop 0
  buffer_load_dwordx4 v4, s[64:67], s14 offen nt lds
  s_add_u32 s14, s14, 524288
  s_add_u32 s16, s16, 16384
  s_cmp_ge_u32 s4, 8
  s_cbranch_scc1 P_Q2
  s_mov_b32 m0, s16
  s_nop 0
  buffer_load_dwordx4 v4, s[64:67], s14 offen nt lds
P_Q2:
  v_lshlrev_b32 v4, 13, v2
  s_bfe_u32 s14, s4, 0x10001
  s_lshl_b32 s14, s14, 3
  v_lshl_or_b32 v5, v2, 1, s14
  v_xor_b32 v5, v5, v3
  v_lshl_add_u32 v4, v5, 4, v4
  s_xor_b32 s15, s9, 3
  s_mul_i32 s15, s15, 1310720
  s_lshl_b32 s14, s8, 8
  s_add_u32 s15, s15, s14
  s_lshl_b32 s14, s4, 15
  s_add_u32 s14, s14, s15
  s_lshl_b32 s16, s4, 10
  s_add_u32 s16, s16, 90112
  s_mov_b32 m0, s16
  s_nop 0
  buffer_load_dwordx4 v4, s[64:67], s14 offen nt lds
  s_add_u32 s14, s14, 524288
  s_add_u32 s16, s16, 16384
  s_mov_b32 m0, s16
  s_nop 0
  buffer_load_dwordx4 v4, s[64:67], s14 offen nt lds
  s_add_u32 s14, s14, 524288
  s_add_u32 s16, s16, 16384
  s_cmp_ge_u32 s4, 8
  s_cbranch_scc1 P_Q3
  s_mov_b32 m0, s16
  s_nop 0
  buffer_load_dwordx4 v4, s[64:67], s14 offen nt lds
P_Q3:
  v_lshlrev_b32 v4, 13, v2
  s_bfe_u32 s14, s4, 0x10001
  s_lshl_b32 s14, s14, 3
  v_lshl_or_b32 v5, v2, 1, s14
  v_xor_b32 v5, v5, v3
  v_lshl_add_u32 v4, v5, 4, v4
  s_xor_b32 s15, s9, 1
  s_mul_i32 s15, s15, 1310720
  s_lshl_b32 s14, s8, 8
  s_add_u32 s15, s15, s14
  s_lshl_b32 s14, s4, 15
  s_add_u32 s14, s14, s15
  s_lshl_b32 s16, s4, 10
  s_add_u32 s16, s16, 131072
  s_mov_b32 m0, s16
  s_nop 0
  buffer_load_dwordx4 v4, s[64:67], s14 offen nt lds
  s_add_u32 s14, s14, 524288
  s_add_u32 s16, s16, 16384
  s_mov_b32 m0, s16
  s_nop 0
  buffer_load_dwordx4 v4, s[64:67], s14 offen nt lds
  s_cmp_ge_u32 s4, 8
  s_cbranch_scc1 P_LOOP
  v_lshlrev_b32 v4, 16, v2
  v_lshl_add_u32 v4, v3, 1, v4
  s_lshl_b32 s14, s4, 5
  s_add_u32 s14, s14, s15
  s_add_u32 s14, s14, 1048576
  buffer_load_ushort v32, v4, s[64:67], s14 offen
  s_add_u32 s14, s14, 8192
  buffer_load_ushort v33, v4, s[64:67], s14 offen
  s_add_u32 s14, s14, 8192
  buffer_load_ushort v34, v4, s[64:67], s14 offen
  s_add_u32 s14, s14, 8192
  buffer_load_ushort v35, v4, s[64:67], s14 offen
  s_add_u32 s14, s14, 8192
  buffer_load_ushort v36, v4, s[64:67], s14 offen
  s_add_u32 s14, s14, 8192
  buffer_load_ushort v37, v4, s[64:67], s14 offen
  s_add_u32 s14, s14, 8192
  buffer_load_ushort v38, v4, s[64:67], s14 offen
  s_add_u32 s14, s14, 8192
  buffer_load_ushort v39, v4, s[64:67], s14 offen
  s_branch P_LOOP
P_LAST:
  s_cmp_ge_u32 s10, 10
  s_cbranch_scc1 END
  s_cmp_lg_u32 s4, 5
  s_cbranch_scc1 END
  s_mov_b32 s59, 1
  s_mov_b32 s3, s10
  s_branch P_CONS
P_FIN:
  s_mov_b32 s64, s52
  s_mov_b32 s65, s53
  s_mov_b32 s66, 1280
  s_mov_b32 s67, 0x00020000
  buffer_store_dword v32, v41, s[64:67], 0 offen
  s_cmp_lg_u32 s10, 0
  s_cbranch_scc1 END
  v_mov_b32 v4, s7
  v_mov_b32 v5, 0
  s_mov_b64 exec, 1
  buffer_store_dword v4, v5, s[60:63], 0 offen
END:
  s_endpgm
.section .rodata,"a"
.p2align 6
.amdhsa_kernel interleave_layers__compressed_kv_cla__glu_gated_geglu__decode_kernel
  .amdhsa_next_free_vgpr 128
  .amdhsa_next_free_sgpr 102
  .amdhsa_accum_offset 128
  .amdhsa_group_segment_fixed_size 0
  .amdhsa_kernarg_size 104
  .amdhsa_user_sgpr_count 2
  .amdhsa_user_sgpr_kernarg_segment_ptr 1
  .amdhsa_system_sgpr_workgroup_id_x 1
.end_amdhsa_kernel
```
